```python
import torch

def _softmax(x, axis=-1):
    return torch.softmax(x, dim=axis)
def _gelu(x):
    return torch.nn.functional.gelu(x, approximate="tanh")
def _silu(x):
    return torch.nn.functional.silu(x)
def _sigmoid(x):
    return torch.sigmoid(x)
def _layernorm(x, axis=-1, eps=1e-5):
    m = x.mean(dim=axis, keepdim=True)
    v = x.var(dim=axis, keepdim=True, unbiased=False)
    return (x - m) / torch.sqrt(v + eps)
def _scatter_add(tgt, idx, src, axis=0):
    return tgt.clone().index_add_(axis, idx, src)
def _segment_sum(src, seg, n):
    out = torch.zeros((n,) + src.shape[1:], dtype=src.dtype)
    return out.index_add_(0, seg, src)
def _pad(x, pw):
    flat = tuple(v for pair in reversed(pw) for v in pair)
    return torch.nn.functional.pad(x, flat)

kernel_name = 'parallel_sum__ssm_conv_s4d__swiglu_ffn__prompt'

def setup_inputs():

    _w = (lambda a: (lambda t: t.to(torch.bfloat16) if t.is_floating_point() else t)(torch.as_tensor(a)))
    def _A_setup():
        Bsz, L, D, N = 1, 2048, 512, 128
        return {
            "u": _w((lambda *s: torch.randn(*s, dtype=torch.bfloat16) * 0.05)(Bsz, L, D)),
            "log_A_real": _w((lambda *s: torch.randn(*s, dtype=torch.bfloat16) * 3.2)(D, N) * 0.5),
            "A_imag": _w((lambda *s: torch.randn(*s, dtype=torch.bfloat16) * 0.1)(D, N) * 3.14),
            "C_real": _w((lambda *s: torch.randn(*s, dtype=torch.bfloat16) * 1.6)(D, N) / N ** 0.5),
            "C_imag": _w((lambda *s: torch.randn(*s, dtype=torch.bfloat16) * 1.6)(D, N) / N ** 0.5),
            "log_dt": _w((lambda *s: torch.randn(*s, dtype=torch.bfloat16) * 0.1)(D) * 0.5 - 4.0),
            "D_skip": _w((lambda *s: torch.randn(*s, dtype=torch.bfloat16) * 0.2)(D)),
        }
    _A_in = _A_setup()

    def _B_setup():
        B, S, D, F = 1, 2048, 512, 1792
        return {
            "x": _w((lambda *s: torch.randn(*s, dtype=torch.bfloat16) * 0.05)(B, S, D)),
            "w_gate": _w((lambda *s: torch.randn(*s, dtype=torch.bfloat16) * 0.05)(D, F)),
            "w_up": _w((lambda *s: torch.randn(*s, dtype=torch.bfloat16) * 0.05)(D, F)),
            "w_down": _w((lambda *s: torch.randn(*s, dtype=torch.bfloat16) * 0.05)(F, D)),
        }
    _B_in = _B_setup()

    return {
        "A_u": _A_in["u"],
        "A_log_A_real": _A_in["log_A_real"],
        "A_A_imag": _A_in["A_imag"],
        "A_C_real": _A_in["C_real"],
        "A_C_imag": _A_in["C_imag"],
        "A_log_dt": _A_in["log_dt"],
        "A_D_skip": _A_in["D_skip"],
        "B_x": _B_in["x"],
        "B_w_gate": _B_in["w_gate"],
        "B_w_up": _B_in["w_up"],
        "B_w_down": _B_in["w_down"],
    }

def reference(A_u, A_log_A_real, A_A_imag, A_C_real, A_C_imag, A_log_dt, A_D_skip, B_x, B_w_gate, B_w_up, B_w_down):
    def _A_ref(u, log_A_real, A_imag, C_real, C_imag, log_dt, D_skip):
        L = u.shape[1]
        dt = torch.exp(log_dt)
        A = -torch.exp(log_A_real) + 1j * A_imag
        C = (C_real + 1j * C_imag) * dt[:, None]
        pos = (lambda x, dt: x.to(dt))(torch.arange(L), log_dt.dtype)
        P = torch.exp((A * dt[:, None])[:, :, None] * pos[None, None, :])
        K = 2.0 * torch.einsum("dn,dnl->dl", C, P).real
        L2 = 2 * L
        u_t = (lambda x, *d: x.permute(*d))(u, 0, 2, 1)
        Kf = (lambda x, *a, **k: torch.fft.rfft(x.float(), *a, **k))(K, L2)
        Uf = (lambda x, *a, **k: torch.fft.rfft(x.float(), *a, **k))(u_t, L2)
        y = (lambda x, *a, **k: torch.fft.irfft(x, *a, **k).to(torch.bfloat16))(Uf * Kf[None, :, :], L2)[:, :, :L]
        y = (lambda x, *d: x.permute(*d))(y, 0, 2, 1)
        return y + u * D_skip[None, None, :]

    def _B_ref(x, w_gate, w_up, w_down):
        g = _silu(x @ w_gate)
        u = x @ w_up
        return (g * u) @ w_down

    x = A_u
    xn = _layernorm(x, axis=-1)
    return x + _A_ref(xn, A_log_A_real, A_A_imag, A_C_real, A_C_imag, A_log_dt, A_D_skip) + _B_ref(xn, B_w_gate, B_w_up, B_w_down)
```

```asm
; @launch kernel=k1_kernel grid=(256,1,1) block=(512,1,1) lds=8320
; @launch kernel=k2_kernel grid=(512,1,1) block=(256,1,1) lds=75392
; @launch kernel=k3_kernel grid=(512,1,1) block=(256,1,1) lds=81920
.amdgcn_target "amdgcn-amd-amdhsa--gfx950"
.text
.globl k1_kernel
.p2align 8
.type k1_kernel,@function
k1_kernel:
    s_cmp_ge_u32 s2, 256
    s_cbranch_scc1 K1_done
    s_load_dwordx2 s[6:7], s[0:1], 104
    s_load_dwordx2 s[32:33], s[0:1], 0
    s_load_dwordx4 s[52:55], s[0:1], 64
    v_and_b32 v1, 63, v0
    v_lshrrev_b32 v2, 6, v0
    s_nop 0
    v_readfirstlane_b32 s58, v2
    s_lshl_b32 s60, s2, 13
    s_lshl_b32 s63, s58, 10
    s_add_u32 s60, s60, s63
    v_lshlrev_b32 v5, 4, v1
    s_waitcnt lgkmcnt(0)
    s_mov_b32 s8, s32
    s_mov_b32 s9, s33
    s_mov_b32 s10, 0x200000
    s_mov_b32 s11, 0x00020000
    s_mov_b32 s12, s6
    s_mov_b32 s13, s7
    s_mov_b32 s14, 0x1200000
    s_mov_b32 s15, 0x00020000
    buffer_load_dwordx4 v[8:11], v5, s[8:11], s60 offen
    v_and_b32 v16, 7, v0
    v_mul_u32_u24 v17, 1040, v16
    v_lshrrev_b32 v18, 4, v0
    v_lshl_add_u32 v17, v18, 5, v17
    v_bfe_u32 v19, v0, 3, 1
    v_lshl_add_u32 v17, v19, 4, v17
    v_lshlrev_b32 v18, 10, v18
    v_lshl_add_u32 v18, v19, 9, v18
    v_lshl_add_u32 v18, v16, 4, v18
    v_lshlrev_b32 v20, 1, v0
    v_lshlrev_b32 v21, 4, v0
    s_mul_i32 s3, s58, 1040
    v_add_u32 v7, s3, v5
    s_waitcnt vmcnt(0)
    s_mov_b32 s64, s52
    s_mov_b32 s65, s53
    s_mov_b32 s66, 0x1c0000
    s_mov_b32 s67, 0x00020000
    buffer_load_dwordx4 v[56:59], v5, s[64:67], s60 offen
    s_mov_b32 s68, s54
    s_mov_b32 s69, s55
    s_mov_b32 s70, 0x1c0000
    s_mov_b32 s71, 0x00020000
    buffer_load_dwordx4 v[60:63], v5, s[68:71], s60 offen
    v_lshlrev_b32 v32, 16, v8
    v_and_b32 v33, 0xffff0000, v8
    v_lshlrev_b32 v34, 16, v9
    v_and_b32 v35, 0xffff0000, v9
    v_lshlrev_b32 v36, 16, v10
    v_and_b32 v37, 0xffff0000, v10
    v_lshlrev_b32 v38, 16, v11
    v_and_b32 v39, 0xffff0000, v11
    v_add_f32 v40, v32, v33
    v_add_f32 v41, v34, v35
    v_add_f32 v42, v36, v37
    v_add_f32 v43, v38, v39
    v_add_f32 v40, v40, v41
    v_add_f32 v42, v42, v43
    v_add_f32 v40, v40, v42
    s_nop 1
    v_add_f32_dpp v40, v40, v40 quad_perm:[1,0,3,2] row_mask:0xf bank_mask:0xf
    s_nop 1
    v_add_f32_dpp v40, v40, v40 quad_perm:[2,3,0,1] row_mask:0xf bank_mask:0xf
    s_nop 1
    v_add_f32_dpp v40, v40, v40 row_half_mirror row_mask:0xf bank_mask:0xf
    s_nop 1
    v_add_f32_dpp v40, v40, v40 row_mirror row_mask:0xf bank_mask:0xf
    s_nop 0
    v_readlane_b32 s80, v40, 0
    v_readlane_b32 s81, v40, 16
    v_readlane_b32 s82, v40, 32
    v_readlane_b32 s83, v40, 48
    v_mov_b32 v40, s80
    v_add_f32 v40, s81, v40
    v_add_f32 v40, s82, v40
    v_add_f32 v40, s83, v40
    v_mul_f32 v41, 0x3b000000, v40
    v_sub_f32 v44, v32, v41
    v_sub_f32 v45, v33, v41
    v_sub_f32 v46, v34, v41
    v_sub_f32 v47, v35, v41
    v_sub_f32 v48, v36, v41
    v_sub_f32 v49, v37, v41
    v_sub_f32 v50, v38, v41
    v_sub_f32 v51, v39, v41
    v_mul_f32 v42, v44, v44
    v_mul_f32 v43, v45, v45
    v_fmac_f32 v42, v46, v46
    v_fmac_f32 v43, v47, v47
    v_fmac_f32 v42, v48, v48
    v_fmac_f32 v43, v49, v49
    v_fmac_f32 v42, v50, v50
    v_fmac_f32 v43, v51, v51
    v_add_f32 v42, v42, v43
    s_nop 1
    v_add_f32_dpp v42, v42, v42 quad_perm:[1,0,3,2] row_mask:0xf bank_mask:0xf
    s_nop 1
    v_add_f32_dpp v42, v42, v42 quad_perm:[2,3,0,1] row_mask:0xf bank_mask:0xf
    s_nop 1
    v_add_f32_dpp v42, v42, v42 row_half_mirror row_mask:0xf bank_mask:0xf
    s_nop 1
    v_add_f32_dpp v42, v42, v42 row_mirror row_mask:0xf bank_mask:0xf
    s_nop 0
    v_readlane_b32 s80, v42, 0
    v_readlane_b32 s81, v42, 16
    v_readlane_b32 s82, v42, 32
    v_readlane_b32 s83, v42, 48
    v_mov_b32 v42, s80
    v_add_f32 v42, s81, v42
    v_add_f32 v42, s82, v42
    v_add_f32 v42, s83, v42
    v_mul_f32 v42, 0x3b000000, v42
    v_cvt_pk_bf16_f32 v43, v41, v42
    v_lshlrev_b32 v52, 16, v43
    v_and_b32 v53, 0xffff0000, v43
    v_add_f32 v53, 0x3727c5ac, v53
    v_cvt_pk_bf16_f32 v53, v53, v53
    v_lshlrev_b32 v53, 16, v53
    v_sqrt_f32 v53, v53
    s_nop 0
    v_cvt_pk_bf16_f32 v53, v53, v53
    v_lshlrev_b32 v54, 16, v53
    v_rcp_f32 v55, v54
    v_sub_f32 v32, v32, v52
    v_sub_f32 v33, v33, v52
    v_cvt_pk_bf16_f32 v32, v32, v33
    v_and_b32 v33, 0xffff0000, v32
    v_lshlrev_b32 v32, 16, v32
    v_mul_f32 v44, v32, v55
    v_mul_f32 v45, v33, v55
    v_fma_f32 v32, -v44, v54, v32
    v_fma_f32 v33, -v45, v54, v33
    v_fma_f32 v44, v32, v55, v44
    v_fma_f32 v45, v33, v55, v45
    v_cvt_pk_bf16_f32 v8, v44, v45
    v_sub_f32 v34, v34, v52
    v_sub_f32 v35, v35, v52
    v_cvt_pk_bf16_f32 v34, v34, v35
    v_and_b32 v35, 0xffff0000, v34
    v_lshlrev_b32 v34, 16, v34
    v_mul_f32 v46, v34, v55
    v_mul_f32 v47, v35, v55
    v_fma_f32 v34, -v46, v54, v34
    v_fma_f32 v35, -v47, v54, v35
    v_fma_f32 v46, v34, v55, v46
    v_fma_f32 v47, v35, v55, v47
    v_cvt_pk_bf16_f32 v9, v46, v47
    v_sub_f32 v36, v36, v52
    v_sub_f32 v37, v37, v52
    v_cvt_pk_bf16_f32 v36, v36, v37
    v_and_b32 v37, 0xffff0000, v36
    v_lshlrev_b32 v36, 16, v36
    v_mul_f32 v48, v36, v55
    v_mul_f32 v49, v37, v55
    v_fma_f32 v36, -v48, v54, v36
    v_fma_f32 v37, -v49, v54, v37
    v_fma_f32 v48, v36, v55, v48
    v_fma_f32 v49, v37, v55, v49
    v_cvt_pk_bf16_f32 v10, v48, v49
    v_sub_f32 v38, v38, v52
    v_sub_f32 v39, v39, v52
    v_cvt_pk_bf16_f32 v38, v38, v39
    v_and_b32 v39, 0xffff0000, v38
    v_lshlrev_b32 v38, 16, v38
    v_mul_f32 v50, v38, v55
    v_mul_f32 v51, v39, v55
    v_fma_f32 v38, -v50, v54, v38
    v_fma_f32 v39, -v51, v54, v39
    v_fma_f32 v50, v38, v55, v50
    v_fma_f32 v51, v39, v55, v51
    v_cvt_pk_bf16_f32 v11, v50, v51
    s_lshr_b32 s75, s60, 10
    ds_write_b128 v7, v[8:11]
    s_lshr_b32 s3, s2, 2
    s_lshl_b32 s3, s3, 15
    s_and_b32 s48, s2, 3
    s_lshl_b32 s48, s48, 7
    s_add_u32 s3, s3, s48
    s_add_u32 s3, s3, 0x0
    s_lshl_b32 s48, s2, 13
    s_add_u32 s48, s48, 0x200000
    s_waitcnt lgkmcnt(0)
    s_barrier
    ds_read_b128 v[8:11], v17
    ds_read_u16 v32, v20 offset:0
    ds_read_u16 v33, v20 offset:1040
    ds_read_u16 v34, v20 offset:2080
    ds_read_u16 v35, v20 offset:3120
    ds_read_u16 v36, v20 offset:4160
    ds_read_u16 v37, v20 offset:5200
    ds_read_u16 v38, v20 offset:6240
    ds_read_u16 v39, v20 offset:7280
    s_waitcnt lgkmcnt(8)
    buffer_store_dwordx4 v[8:11], v18, s[12:15], s3 offen
    s_waitcnt lgkmcnt(0)
    v_lshlrev_b32 v32, 16, v32
    v_lshlrev_b32 v33, 16, v33
    v_lshlrev_b32 v34, 16, v34
    v_lshlrev_b32 v35, 16, v35
    v_lshlrev_b32 v36, 16, v36
    v_lshlrev_b32 v37, 16, v37
    v_lshlrev_b32 v38, 16, v38
    v_lshlrev_b32 v39, 16, v39
    v_cvt_pkrtz_f16_f32 v12, v39, v38
    v_cvt_pkrtz_f16_f32 v13, v37, v36
    v_cvt_pkrtz_f16_f32 v14, v35, v34
    v_cvt_pkrtz_f16_f32 v15, v33, v32
    buffer_store_dwordx4 v[12:15], v21, s[12:15], s48 offen
K1_done:
    s_endpgm
.section .rodata,"a"
.p2align 6
.amdhsa_kernel k1_kernel
  .amdhsa_next_free_vgpr 72
  .amdhsa_next_free_sgpr 96
  .amdhsa_accum_offset 72
  .amdhsa_group_segment_fixed_size 0
  .amdhsa_kernarg_size 112
  .amdhsa_user_sgpr_count 2
  .amdhsa_user_sgpr_kernarg_segment_ptr 1
  .amdhsa_system_sgpr_workgroup_id_x 1
  .amdhsa_float_denorm_mode_32 3
.end_amdhsa_kernel
.text
.globl k2_kernel
.p2align 8
.type k2_kernel,@function
k2_kernel:
    s_cmp_ge_u32 s2, 512
    s_cbranch_scc1 K2_done
    s_load_dwordx2 s[4:5], s[0:1], 104
    v_and_b32 v1, 63, v0
    v_lshrrev_b32 v2, 6, v0
    v_and_b32 v3, 15, v1
    v_lshrrev_b32 v4, 4, v1
    v_readfirstlane_b32 s16, v2
    v_lshlrev_b32 v7, 4, v1
    s_cmp_ge_u32 s2, 256
    s_cbranch_scc1 K2_kgen
    s_and_b32 s2, s2, 0xff
    s_load_dwordx4 s[24:27], s[0:1], 64
    s_load_dwordx2 s[28:29], s[0:1], 80
    s_and_b32 s19, s2, 7
    s_lshr_b32 s20, s2, 3
    s_and_b32 s17, s19, 3
    s_lshl_b32 s17, s17, 2
    s_and_b32 s21, s20, 3
    s_add_u32 s17, s17, s21
    s_lshr_b32 s18, s19, 2
    s_lshl_b32 s18, s18, 3
    s_lshr_b32 s21, s20, 2
    s_add_u32 s18, s18, s21
    s_and_b32 s31, s16, 1
    s_lshr_b32 s32, s16, 1
    s_mul_i32 s38, s17, 224
    s_movk_i32 s39, 4682
    s_lshl_b32 s33, s32, 8
    v_add_u32 v15, 0, v1
    v_add_u32 v15, s33, v15
    v_mul_lo_u32 v16, v15, s39
    v_lshrrev_b32 v16, 16, v16
    v_mul_u32_u24 v17, 14, v16
    v_sub_u32 v17, v15, v17
    v_mul_u32_u24 v16, 3584, v16
    v_lshl_add_u32 v16, v17, 4, v16
    v_add_u32 v8, s38, v16
    v_add_u32 v15, 64, v1
    v_add_u32 v15, s33, v15
    v_mul_lo_u32 v16, v15, s39
    v_lshrrev_b32 v16, 16, v16
    v_mul_u32_u24 v17, 14, v16
    v_sub_u32 v17, v15, v17
    v_mul_u32_u24 v16, 3584, v16
    v_lshl_add_u32 v16, v17, 4, v16
    v_add_u32 v9, s38, v16
    v_add_u32 v15, 128, v1
    v_add_u32 v15, s33, v15
    v_mul_lo_u32 v16, v15, s39
    v_lshrrev_b32 v16, 16, v16
    v_mul_u32_u24 v17, 14, v16
    v_sub_u32 v17, v15, v17
    v_mul_u32_u24 v16, 3584, v16
    v_lshl_add_u32 v16, v17, 4, v16
    v_add_u32 v10, s38, v16
    v_add_u32 v15, 192, v1
    v_add_u32 v15, s33, v15
    s_lshl_b32 s34, s32, 6
    v_subrev_u32 v15, s34, v15
    v_mul_lo_u32 v16, v15, s39
    v_lshrrev_b32 v16, 16, v16
    v_mul_u32_u24 v17, 14, v16
    v_sub_u32 v17, v15, v17
    v_mul_u32_u24 v16, 3584, v16
    v_lshl_add_u32 v16, v17, 4, v16
    v_add_u32 v11, s38, v16
    s_mul_i32 s40, s31, 7296
    s_lshl_b32 s34, s32, 12
    s_add_u32 s40, s40, s34
    s_lshl_b32 s34, s32, 10
    s_sub_u32 s52, 3072, s34
    s_lshl_b32 s43, s18, 3
    s_lshl_b32 s44, s16, 1
    s_add_u32 s43, s43, s44
    s_lshl_b32 s44, s43, 14
    s_add_u32 s44, s44, 0x0
    s_waitcnt lgkmcnt(0)
    s_mov_b32 s8, s4
    s_mov_b32 s9, s5
    s_mov_b32 s10, 0x1200000
    s_mov_b32 s11, 0x00020000
    s_cmp_eq_u32 s31, 0
    s_cselect_b32 s12, s24, s26
    s_cselect_b32 s13, s25, s27
    s_mov_b32 s14, 1835008
    s_mov_b32 s15, 0x00020000
    s_mov_b32 s56, s28
    s_mov_b32 s57, s29
    s_mov_b32 s58, 0x1c0000
    s_mov_b32 s59, 0x00020000
    s_mov_b32 s41, 0
    s_add_u32 s42, s40, 0
    s_mov_b32 m0, s42
    s_nop 0
    buffer_load_dwordx4 v8, s[12:15], s41 offen lds
    s_mov_b32 s41, 0
    s_add_u32 s42, s40, 1024
    s_mov_b32 m0, s42
    s_nop 0
    buffer_load_dwordx4 v9, s[12:15], s41 offen lds
    s_mov_b32 s41, 0
    s_add_u32 s42, s40, 2048
    s_mov_b32 m0, s42
    s_nop 0
    buffer_load_dwordx4 v10, s[12:15], s41 offen lds
    s_mov_b32 s41, 0
    s_add_u32 s42, s40, s52
    s_add_u32 s42, s42, 0
    s_mov_b32 m0, s42
    s_nop 0
    buffer_load_dwordx4 v11, s[12:15], s41 offen lds
    s_add_u32 s45, s44, 0
    buffer_load_dwordx4 v[176:179], v7, s[8:11], s45 offen
    s_add_u32 s45, s44, 1024
    buffer_load_dwordx4 v[180:183], v7, s[8:11], s45 offen
    s_mov_b32 s41, 114688
    s_add_u32 s42, s40, 14464
    s_mov_b32 m0, s42
    s_nop 0
    buffer_load_dwordx4 v8, s[12:15], s41 offen lds
    s_mov_b32 s41, 114688
    s_add_u32 s42, s40, 15488
    s_mov_b32 m0, s42
    s_nop 0
    buffer_load_dwordx4 v9, s[12:15], s41 offen lds
    s_mov_b32 s41, 114688
    s_add_u32 s42, s40, 16512
    s_mov_b32 m0, s42
    s_nop 0
    buffer_load_dwordx4 v10, s[12:15], s41 offen lds
    s_mov_b32 s41, 114688
    s_add_u32 s42, s40, s52
    s_add_u32 s42, s42, 14464
    s_mov_b32 m0, s42
    s_nop 0
    buffer_load_dwordx4 v11, s[12:15], s41 offen lds
    s_add_u32 s45, s44, 2048
    buffer_load_dwordx4 v[184:187], v7, s[8:11], s45 offen
    s_add_u32 s45, s44, 3072
    buffer_load_dwordx4 v[188:191], v7, s[8:11], s45 offen
    v_lshrrev_b32 v15, 2, v3
    v_lshrrev_b32 v16, 1, v4
    v_lshl_add_u32 v15, v16, 3, v15
    v_mul_u32_u24 v15, 224, v15
    v_and_b32 v16, 3, v1
    v_lshl_add_u32 v26, v16, 3, v15
    v_and_b32 v16, 1, v4
    v_mul_u32_u24 v16, 7296, v16
    v_add_u32 v26, v26, v16
    v_add_u32 v27, 43392, v26
    s_waitcnt vmcnt(6)
    s_barrier
    ds_read_b64_tr_b16 v[32:33], v26 offset:0
    ds_read_b64_tr_b16 v[34:35], v26 offset:896
    ds_read_b64_tr_b16 v[36:37], v26 offset:32
    ds_read_b64_tr_b16 v[38:39], v26 offset:928
    ds_read_b64_tr_b16 v[40:41], v26 offset:64
    ds_read_b64_tr_b16 v[42:43], v26 offset:960
    ds_read_b64_tr_b16 v[44:45], v26 offset:96
    ds_read_b64_tr_b16 v[46:47], v26 offset:992
    ds_read_b64_tr_b16 v[48:49], v26 offset:128
    ds_read_b64_tr_b16 v[50:51], v26 offset:1024
    ds_read_b64_tr_b16 v[52:53], v26 offset:160
    ds_read_b64_tr_b16 v[54:55], v26 offset:1056
    s_waitcnt lgkmcnt(8)
    v_mfma_f32_32x32x16_bf16 v[64:79], v[32:35], v[176:179], 0
    ds_read_b64_tr_b16 v[56:57], v26 offset:192
    ds_read_b64_tr_b16 v[58:59], v26 offset:1088
    s_mov_b32 s41, 229376
    s_add_u32 s42, s40, 28928
    s_mov_b32 m0, s42
    s_nop 0
    buffer_load_dwordx4 v8, s[12:15], s41 offen lds
    s_mov_b32 s41, 229376
    s_add_u32 s42, s40, 29952
    s_mov_b32 m0, s42
    s_nop 0
    buffer_load_dwordx4 v9, s[12:15], s41 offen lds
    v_mfma_f32_32x32x16_bf16 v[80:95], v[36:39], v[176:179], 0
    ds_read_b64_tr_b16 v[60:61], v26 offset:3584
    ds_read_b64_tr_b16 v[62:63], v26 offset:4480
    s_mov_b32 s41, 229376
    s_add_u32 s42, s40, 30976
    s_mov_b32 m0, s42
    s_nop 0
    buffer_load_dwordx4 v10, s[12:15], s41 offen lds
    s_mov_b32 s41, 229376
    s_add_u32 s42, s40, s52
    s_add_u32 s42, s42, 28928
    s_mov_b32 m0, s42
    s_nop 0
    buffer_load_dwordx4 v11, s[12:15], s41 offen lds
    s_waitcnt lgkmcnt(8)
    v_mfma_f32_32x32x16_bf16 v[96:111], v[40:43], v[176:179], 0
    ds_read_b64_tr_b16 v[32:33], v26 offset:3616
    ds_read_b64_tr_b16 v[34:35], v26 offset:4512
    s_add_u32 s45, s44, 4096
    buffer_load_dwordx4 v[192:195], v7, s[8:11], s45 offen
    s_add_u32 s45, s44, 5120
    buffer_load_dwordx4 v[196:199], v7, s[8:11], s45 offen
    v_mfma_f32_32x32x16_bf16 v[112:127], v[44:47], v[176:179], 0
    ds_read_b64_tr_b16 v[36:37], v26 offset:3648
    ds_read_b64_tr_b16 v[38:39], v26 offset:4544
    s_mov_b32 s41, 344064
    s_add_u32 s42, s40, 43392
    s_mov_b32 m0, s42
    s_nop 0
    buffer_load_dwordx4 v8, s[12:15], s41 offen lds
    s_mov_b32 s41, 344064
    s_add_u32 s42, s40, 44416
    s_mov_b32 m0, s42
    s_nop 0
    buffer_load_dwordx4 v9, s[12:15], s41 offen lds
    s_waitcnt lgkmcnt(8)
    v_mfma_f32_32x32x16_bf16 v[128:143], v[48:51], v[176:179], 0
    ds_read_b64_tr_b16 v[40:41], v26 offset:3680
    ds_read_b64_tr_b16 v[42:43], v26 offset:4576
    s_mov_b32 s41, 344064
    s_add_u32 s42, s40, 45440
    s_mov_b32 m0, s42
    s_nop 0
    buffer_load_dwordx4 v10, s[12:15], s41 offen lds
    s_mov_b32 s41, 344064
    s_add_u32 s42, s40, s52
    s_add_u32 s42, s42, 43392
    s_mov_b32 m0, s42
    s_nop 0
    buffer_load_dwordx4 v11, s[12:15], s41 offen lds
    v_mfma_f32_32x32x16_bf16 v[144:159], v[52:55], v[176:179], 0
    ds_read_b64_tr_b16 v[44:45], v26 offset:3712
    ds_read_b64_tr_b16 v[46:47], v26 offset:4608
    s_add_u32 s45, s44, 6144
    buffer_load_dwordx4 v[200:203], v7, s[8:11], s45 offen
    s_add_u32 s45, s44, 7168
    buffer_load_dwordx4 v[204:207], v7, s[8:11], s45 offen
    s_waitcnt lgkmcnt(8)
    v_mfma_f32_32x32x16_bf16 v[160:175], v[56:59], v[176:179], 0
    ds_read_b64_tr_b16 v[48:49], v26 offset:3744
    ds_read_b64_tr_b16 v[50:51], v26 offset:4640
    s_waitcnt vmcnt(12)
    s_barrier
    v_mfma_f32_32x32x16_bf16 v[64:79], v[60:63], v[180:183], v[64:79]
    ds_read_b64_tr_b16 v[52:53], v26 offset:3776
    ds_read_b64_tr_b16 v[54:55], v26 offset:4672
    s_mov_b32 s41, 458752
    s_add_u32 s42, s40, 57856
    s_mov_b32 m0, s42
    s_nop 0
    buffer_load_dwordx4 v8, s[12:15], s41 offen lds
    s_waitcnt lgkmcnt(8)
    v_mfma_f32_32x32x16_bf16 v[80:95], v[32:35], v[180:183], v[80:95]
    ds_read_b64_tr_b16 v[56:57], v26 offset:14464
    ds_read_b64_tr_b16 v[58:59], v26 offset:15360
    s_mov_b32 s41, 458752
    s_add_u32 s42, s40, 58880
    s_mov_b32 m0, s42
    s_nop 0
    buffer_load_dwordx4 v9, s[12:15], s41 offen lds
    v_mfma_f32_32x32x16_bf16 v[96:111], v[36:39], v[180:183], v[96:111]
    ds_read_b64_tr_b16 v[60:61], v26 offset:14496
    ds_read_b64_tr_b16 v[62:63], v26 offset:15392
    s_mov_b32 s41, 458752
    s_add_u32 s42, s40, 59904
    s_mov_b32 m0, s42
    s_nop 0
    buffer_load_dwordx4 v10, s[12:15], s41 offen lds
    s_waitcnt lgkmcnt(8)
    v_mfma_f32_32x32x16_bf16 v[112:127], v[40:43], v[180:183], v[112:127]
    ds_read_b64_tr_b16 v[32:33], v26 offset:14528
    ds_read_b64_tr_b16 v[34:35], v26 offset:15424
    s_mov_b32 s41, 458752
    s_add_u32 s42, s40, s52
    s_add_u32 s42, s42, 57856
    s_mov_b32 m0, s42
    s_nop 0
    buffer_load_dwordx4 v11, s[12:15], s41 offen lds
    v_mfma_f32_32x32x16_bf16 v[128:143], v[44:47], v[180:183], v[128:143]
    ds_read_b64_tr_b16 v[36:37], v26 offset:14560
    ds_read_b64_tr_b16 v[38:39], v26 offset:15456
    s_add_u32 s45, s44, 8192
    buffer_load_dwordx4 v[208:211], v7, s[8:11], s45 offen
    s_waitcnt lgkmcnt(8)
    v_mfma_f32_32x32x16_bf16 v[144:159], v[48:51], v[180:183], v[144:159]
    ds_read_b64_tr_b16 v[40:41], v26 offset:14592
    ds_read_b64_tr_b16 v[42:43], v26 offset:15488
    s_add_u32 s45, s44, 9216
    buffer_load_dwordx4 v[212:215], v7, s[8:11], s45 offen
    v_mfma_f32_32x32x16_bf16 v[160:175], v[52:55], v[180:183], v[160:175]
    ds_read_b64_tr_b16 v[44:45], v26 offset:14624
    ds_read_b64_tr_b16 v[46:47], v26 offset:15520
    s_waitcnt lgkmcnt(8)
    v_mfma_f32_32x32x16_bf16 v[64:79], v[56:59], v[184:187], v[64:79]
    ds_read_b64_tr_b16 v[48:49], v26 offset:14656
    ds_read_b64_tr_b16 v[50:51], v26 offset:15552
    v_mfma_f32_32x32x16_bf16 v[80:95], v[60:63], v[184:187], v[80:95]
    ds_read_b64_tr_b16 v[52:53], v26 offset:18048
    ds_read_b64_tr_b16 v[54:55], v26 offset:18944
    s_waitcnt lgkmcnt(8)
    v_mfma_f32_32x32x16_bf16 v[96:111], v[32:35], v[184:187], v[96:111]
    ds_read_b64_tr_b16 v[56:57], v26 offset:18080
    ds_read_b64_tr_b16 v[58:59], v26 offset:18976
    v_mfma_f32_32x32x16_bf16 v[112:127], v[36:39], v[184:187], v[112:127]
    ds_read_b64_tr_b16 v[60:61], v26 offset:18112
    ds_read_b64_tr_b16 v[62:63], v26 offset:19008
    s_waitcnt lgkmcnt(8)
    v_mfma_f32_32x32x16_bf16 v[128:143], v[40:43], v[184:187], v[128:143]
    ds_read_b64_tr_b16 v[32:33], v26 offset:18144
    ds_read_b64_tr_b16 v[34:35], v26 offset:19040
    v_mfma_f32_32x32x16_bf16 v[144:159], v[44:47], v[184:187], v[144:159]
    ds_read_b64_tr_b16 v[36:37], v26 offset:18176
    ds_read_b64_tr_b16 v[38:39], v26 offset:19072
    s_waitcnt lgkmcnt(8)
    v_mfma_f32_32x32x16_bf16 v[160:175], v[48:51], v[184:187], v[160:175]
    ds_read_b64_tr_b16 v[40:41], v26 offset:18208
    ds_read_b64_tr_b16 v[42:43], v26 offset:19104
    s_waitcnt vmcnt(12)
    s_barrier
    v_mfma_f32_32x32x16_bf16 v[64:79], v[52:55], v[188:191], v[64:79]
    ds_read_b64_tr_b16 v[44:45], v26 offset:18240
    ds_read_b64_tr_b16 v[46:47], v26 offset:19136
    s_mov_b32 s41, 573440
    s_add_u32 s42, s40, 0
    s_mov_b32 m0, s42
    s_nop 0
    buffer_load_dwordx4 v8, s[12:15], s41 offen lds
    s_waitcnt lgkmcnt(8)
    v_mfma_f32_32x32x16_bf16 v[80:95], v[56:59], v[188:191], v[80:95]
    ds_read_b64_tr_b16 v[48:49], v26 offset:28928
    ds_read_b64_tr_b16 v[50:51], v26 offset:29824
    s_mov_b32 s41, 573440
    s_add_u32 s42, s40, 1024
    s_mov_b32 m0, s42
    s_nop 0
    buffer_load_dwordx4 v9, s[12:15], s41 offen lds
    v_mfma_f32_32x32x16_bf16 v[96:111], v[60:63], v[188:191], v[96:111]
    ds_read_b64_tr_b16 v[52:53], v26 offset:28960
    ds_read_b64_tr_b16 v[54:55], v26 offset:29856
    s_mov_b32 s41, 573440
    s_add_u32 s42, s40, 2048
    s_mov_b32 m0, s42
    s_nop 0
    buffer_load_dwordx4 v10, s[12:15], s41 offen lds
    s_waitcnt lgkmcnt(8)
    v_mfma_f32_32x32x16_bf16 v[112:127], v[32:35], v[188:191], v[112:127]
    ds_read_b64_tr_b16 v[56:57], v26 offset:28992
    ds_read_b64_tr_b16 v[58:59], v26 offset:29888
    s_mov_b32 s41, 573440
    s_add_u32 s42, s40, s52
    s_add_u32 s42, s42, 0
    s_mov_b32 m0, s42
    s_nop 0
    buffer_load_dwordx4 v11, s[12:15], s41 offen lds
    v_mfma_f32_32x32x16_bf16 v[128:143], v[36:39], v[188:191], v[128:143]
    ds_read_b64_tr_b16 v[60:61], v26 offset:29024
    ds_read_b64_tr_b16 v[62:63], v26 offset:29920
    s_add_u32 s45, s44, 10240
    buffer_load_dwordx4 v[176:179], v7, s[8:11], s45 offen
    s_waitcnt lgkmcnt(8)
    v_mfma_f32_32x32x16_bf16 v[144:159], v[40:43], v[188:191], v[144:159]
    ds_read_b64_tr_b16 v[32:33], v26 offset:29056
    ds_read_b64_tr_b16 v[34:35], v26 offset:29952
    s_add_u32 s45, s44, 11264
    buffer_load_dwordx4 v[180:183], v7, s[8:11], s45 offen
    v_mfma_f32_32x32x16_bf16 v[160:175], v[44:47], v[188:191], v[160:175]
    ds_read_b64_tr_b16 v[36:37], v26 offset:29088
    ds_read_b64_tr_b16 v[38:39], v26 offset:29984
    s_waitcnt lgkmcnt(8)
    v_mfma_f32_32x32x16_bf16 v[64:79], v[48:51], v[192:195], v[64:79]
    ds_read_b64_tr_b16 v[40:41], v26 offset:29120
    ds_read_b64_tr_b16 v[42:43], v26 offset:30016
    v_mfma_f32_32x32x16_bf16 v[80:95], v[52:55], v[192:195], v[80:95]
    ds_read_b64_tr_b16 v[44:45], v26 offset:32512
    ds_read_b64_tr_b16 v[46:47], v26 offset:33408
    s_waitcnt lgkmcnt(8)
    v_mfma_f32_32x32x16_bf16 v[96:111], v[56:59], v[192:195], v[96:111]
    ds_read_b64_tr_b16 v[48:49], v26 offset:32544
    ds_read_b64_tr_b16 v[50:51], v26 offset:33440
    v_mfma_f32_32x32x16_bf16 v[112:127], v[60:63], v[192:195], v[112:127]
    ds_read_b64_tr_b16 v[52:53], v26 offset:32576
    ds_read_b64_tr_b16 v[54:55], v26 offset:33472
    s_waitcnt lgkmcnt(8)
    v_mfma_f32_32x32x16_bf16 v[128:143], v[32:35], v[192:195], v[128:143]
    ds_read_b64_tr_b16 v[56:57], v26 offset:32608
    ds_read_b64_tr_b16 v[58:59], v26 offset:33504
    v_mfma_f32_32x32x16_bf16 v[144:159], v[36:39], v[192:195], v[144:159]
    ds_read_b64_tr_b16 v[60:61], v26 offset:32640
    ds_read_b64_tr_b16 v[62:63], v26 offset:33536
    s_waitcnt lgkmcnt(8)
    v_mfma_f32_32x32x16_bf16 v[160:175], v[40:43], v[192:195], v[160:175]
    ds_read_b64_tr_b16 v[32:33], v26 offset:32672
    ds_read_b64_tr_b16 v[34:35], v26 offset:33568
    s_waitcnt vmcnt(12)
    s_barrier
    v_mfma_f32_32x32x16_bf16 v[64:79], v[44:47], v[196:199], v[64:79]
    ds_read_b64_tr_b16 v[36:37], v26 offset:32704
    ds_read_b64_tr_b16 v[38:39], v26 offset:33600
    s_mov_b32 s41, 688128
    s_add_u32 s42, s40, 14464
    s_mov_b32 m0, s42
    s_nop 0
    buffer_load_dwordx4 v8, s[12:15], s41 offen lds
    s_waitcnt lgkmcnt(8)
    v_mfma_f32_32x32x16_bf16 v[80:95], v[48:51], v[196:199], v[80:95]
    ds_read_b64_tr_b16 v[40:41], v27 offset:0
    ds_read_b64_tr_b16 v[42:43], v27 offset:896
    s_mov_b32 s41, 688128
    s_add_u32 s42, s40, 15488
    s_mov_b32 m0, s42
    s_nop 0
    buffer_load_dwordx4 v9, s[12:15], s41 offen lds
    v_mfma_f32_32x32x16_bf16 v[96:111], v[52:55], v[196:199], v[96:111]
    ds_read_b64_tr_b16 v[44:45], v27 offset:32
    ds_read_b64_tr_b16 v[46:47], v27 offset:928
    s_mov_b32 s41, 688128
    s_add_u32 s42, s40, 16512
    s_mov_b32 m0, s42
    s_nop 0
    buffer_load_dwordx4 v10, s[12:15], s41 offen lds
    s_waitcnt lgkmcnt(8)
    v_mfma_f32_32x32x16_bf16 v[112:127], v[56:59], v[196:199], v[112:127]
    ds_read_b64_tr_b16 v[48:49], v27 offset:64
    ds_read_b64_tr_b16 v[50:51], v27 offset:960
    s_mov_b32 s41, 688128
    s_add_u32 s42, s40, s52
    s_add_u32 s42, s42, 14464
    s_mov_b32 m0, s42
    s_nop 0
    buffer_load_dwordx4 v11, s[12:15], s41 offen lds
    v_mfma_f32_32x32x16_bf16 v[128:143], v[60:63], v[196:199], v[128:143]
    ds_read_b64_tr_b16 v[52:53], v27 offset:96
    ds_read_b64_tr_b16 v[54:55], v27 offset:992
    s_add_u32 s45, s44, 12288
    buffer_load_dwordx4 v[184:187], v7, s[8:11], s45 offen
    s_waitcnt lgkmcnt(8)
    v_mfma_f32_32x32x16_bf16 v[144:159], v[32:35], v[196:199], v[144:159]
    ds_read_b64_tr_b16 v[56:57], v27 offset:128
    ds_read_b64_tr_b16 v[58:59], v27 offset:1024
    s_add_u32 s45, s44, 13312
    buffer_load_dwordx4 v[188:191], v7, s[8:11], s45 offen
    v_mfma_f32_32x32x16_bf16 v[160:175], v[36:39], v[196:199], v[160:175]
    ds_read_b64_tr_b16 v[60:61], v27 offset:160
    ds_read_b64_tr_b16 v[62:63], v27 offset:1056
    s_waitcnt lgkmcnt(8)
    v_mfma_f32_32x32x16_bf16 v[64:79], v[40:43], v[200:203], v[64:79]
    ds_read_b64_tr_b16 v[32:33], v27 offset:192
    ds_read_b64_tr_b16 v[34:35], v27 offset:1088
    v_mfma_f32_32x32x16_bf16 v[80:95], v[44:47], v[200:203], v[80:95]
    ds_read_b64_tr_b16 v[36:37], v27 offset:3584
    ds_read_b64_tr_b16 v[38:39], v27 offset:4480
    s_waitcnt lgkmcnt(8)
    v_mfma_f32_32x32x16_bf16 v[96:111], v[48:51], v[200:203], v[96:111]
    ds_read_b64_tr_b16 v[40:41], v27 offset:3616
    ds_read_b64_tr_b16 v[42:43], v27 offset:4512
    v_mfma_f32_32x32x16_bf16 v[112:127], v[52:55], v[200:203], v[112:127]
    ds_read_b64_tr_b16 v[44:45], v27 offset:3648
    ds_read_b64_tr_b16 v[46:47], v27 offset:4544
    s_waitcnt lgkmcnt(8)
    v_mfma_f32_32x32x16_bf16 v[128:143], v[56:59], v[200:203], v[128:143]
    ds_read_b64_tr_b16 v[48:49], v27 offset:3680
    ds_read_b64_tr_b16 v[50:51], v27 offset:4576
    v_mfma_f32_32x32x16_bf16 v[144:159], v[60:63], v[200:203], v[144:159]
    ds_read_b64_tr_b16 v[52:53], v27 offset:3712
    ds_read_b64_tr_b16 v[54:55], v27 offset:4608
    s_waitcnt lgkmcnt(8)
    v_mfma_f32_32x32x16_bf16 v[160:175], v[32:35], v[200:203], v[160:175]
    ds_read_b64_tr_b16 v[56:57], v27 offset:3744
    ds_read_b64_tr_b16 v[58:59], v27 offset:4640
    s_waitcnt vmcnt(12)
    s_barrier
    v_mfma_f32_32x32x16_bf16 v[64:79], v[36:39], v[204:207], v[64:79]
    ds_read_b64_tr_b16 v[60:61], v27 offset:3776
    ds_read_b64_tr_b16 v[62:63], v27 offset:4672
    s_mov_b32 s41, 802816
    s_add_u32 s42, s40, 28928
    s_mov_b32 m0, s42
    s_nop 0
    buffer_load_dwordx4 v8, s[12:15], s41 offen lds
    s_waitcnt lgkmcnt(8)
    v_mfma_f32_32x32x16_bf16 v[80:95], v[40:43], v[204:207], v[80:95]
    ds_read_b64_tr_b16 v[32:33], v27 offset:14464
    ds_read_b64_tr_b16 v[34:35], v27 offset:15360
    s_mov_b32 s41, 802816
    s_add_u32 s42, s40, 29952
    s_mov_b32 m0, s42
    s_nop 0
    buffer_load_dwordx4 v9, s[12:15], s41 offen lds
    v_mfma_f32_32x32x16_bf16 v[96:111], v[44:47], v[204:207], v[96:111]
    ds_read_b64_tr_b16 v[36:37], v27 offset:14496
    ds_read_b64_tr_b16 v[38:39], v27 offset:15392
    s_mov_b32 s41, 802816
    s_add_u32 s42, s40, 30976
    s_mov_b32 m0, s42
    s_nop 0
    buffer_load_dwordx4 v10, s[12:15], s41 offen lds
    s_waitcnt lgkmcnt(8)
    v_mfma_f32_32x32x16_bf16 v[112:127], v[48:51], v[204:207], v[112:127]
    ds_read_b64_tr_b16 v[40:41], v27 offset:14528
    ds_read_b64_tr_b16 v[42:43], v27 offset:15424
    s_mov_b32 s41, 802816
    s_add_u32 s42, s40, s52
    s_add_u32 s42, s42, 28928
    s_mov_b32 m0, s42
    s_nop 0
    buffer_load_dwordx4 v11, s[12:15], s41 offen lds
    v_mfma_f32_32x32x16_bf16 v[128:143], v[52:55], v[204:207], v[128:143]
    ds_read_b64_tr_b16 v[44:45], v27 offset:14560
    ds_read_b64_tr_b16 v[46:47], v27 offset:15456
    s_add_u32 s45, s44, 14336
    buffer_load_dwordx4 v[192:195], v7, s[8:11], s45 offen
    s_waitcnt lgkmcnt(8)
    v_mfma_f32_32x32x16_bf16 v[144:159], v[56:59], v[204:207], v[144:159]
    ds_read_b64_tr_b16 v[48:49], v27 offset:14592
    ds_read_b64_tr_b16 v[50:51], v27 offset:15488
    s_add_u32 s45, s44, 15360
    buffer_load_dwordx4 v[196:199], v7, s[8:11], s45 offen
    v_mfma_f32_32x32x16_bf16 v[160:175], v[60:63], v[204:207], v[160:175]
    ds_read_b64_tr_b16 v[52:53], v27 offset:14624
    ds_read_b64_tr_b16 v[54:55], v27 offset:15520
    s_waitcnt lgkmcnt(8)
    v_mfma_f32_32x32x16_bf16 v[64:79], v[32:35], v[208:211], v[64:79]
    ds_read_b64_tr_b16 v[56:57], v27 offset:14656
    ds_read_b64_tr_b16 v[58:59], v27 offset:15552
    v_mfma_f32_32x32x16_bf16 v[80:95], v[36:39], v[208:211], v[80:95]
    ds_read_b64_tr_b16 v[60:61], v27 offset:18048
    ds_read_b64_tr_b16 v[62:63], v27 offset:18944
    s_waitcnt lgkmcnt(8)
    v_mfma_f32_32x32x16_bf16 v[96:111], v[40:43], v[208:211], v[96:111]
    ds_read_b64_tr_b16 v[32:33], v27 offset:18080
    ds_read_b64_tr_b16 v[34:35], v27 offset:18976
    v_mfma_f32_32x32x16_bf16 v[112:127], v[44:47], v[208:211], v[112:127]
    ds_read_b64_tr_b16 v[36:37], v27 offset:18112
    ds_read_b64_tr_b16 v[38:39], v27 offset:19008
    s_waitcnt lgkmcnt(8)
    v_mfma_f32_32x32x16_bf16 v[128:143], v[48:51], v[208:211], v[128:143]
    ds_read_b64_tr_b16 v[40:41], v27 offset:18144
    ds_read_b64_tr_b16 v[42:43], v27 offset:19040
    v_mfma_f32_32x32x16_bf16 v[144:159], v[52:55], v[208:211], v[144:159]
    ds_read_b64_tr_b16 v[44:45], v27 offset:18176
    ds_read_b64_tr_b16 v[46:47], v27 offset:19072
    s_waitcnt lgkmcnt(8)
    v_mfma_f32_32x32x16_bf16 v[160:175], v[56:59], v[208:211], v[160:175]
    ds_read_b64_tr_b16 v[48:49], v27 offset:18208
    ds_read_b64_tr_b16 v[50:51], v27 offset:19104
    s_waitcnt vmcnt(12)
    s_barrier
    v_mfma_f32_32x32x16_bf16 v[64:79], v[60:63], v[212:215], v[64:79]
    ds_read_b64_tr_b16 v[52:53], v27 offset:18240
    ds_read_b64_tr_b16 v[54:55], v27 offset:19136
    s_mov_b32 s41, 917504
    s_add_u32 s42, s40, 43392
    s_mov_b32 m0, s42
    s_nop 0
    buffer_load_dwordx4 v8, s[12:15], s41 offen lds
    s_waitcnt lgkmcnt(8)
    v_mfma_f32_32x32x16_bf16 v[80:95], v[32:35], v[212:215], v[80:95]
    ds_read_b64_tr_b16 v[56:57], v26 offset:0
    ds_read_b64_tr_b16 v[58:59], v26 offset:896
    s_mov_b32 s41, 917504
    s_add_u32 s42, s40, 44416
    s_mov_b32 m0, s42
    s_nop 0
    buffer_load_dwordx4 v9, s[12:15], s41 offen lds
    v_mfma_f32_32x32x16_bf16 v[96:111], v[36:39], v[212:215], v[96:111]
    ds_read_b64_tr_b16 v[60:61], v26 offset:32
    ds_read_b64_tr_b16 v[62:63], v26 offset:928
    s_mov_b32 s41, 917504
    s_add_u32 s42, s40, 45440
    s_mov_b32 m0, s42
    s_nop 0
    buffer_load_dwordx4 v10, s[12:15], s41 offen lds
    s_waitcnt lgkmcnt(8)
    v_mfma_f32_32x32x16_bf16 v[112:127], v[40:43], v[212:215], v[112:127]
    ds_read_b64_tr_b16 v[32:33], v26 offset:64
    ds_read_b64_tr_b16 v[34:35], v26 offset:960
    s_mov_b32 s41, 917504
    s_add_u32 s42, s40, s52
    s_add_u32 s42, s42, 43392
    s_mov_b32 m0, s42
    s_nop 0
    buffer_load_dwordx4 v11, s[12:15], s41 offen lds
    v_mfma_f32_32x32x16_bf16 v[128:143], v[44:47], v[212:215], v[128:143]
    ds_read_b64_tr_b16 v[36:37], v26 offset:96
    ds_read_b64_tr_b16 v[38:39], v26 offset:992
    s_add_u32 s45, s44, 16384
    buffer_load_dwordx4 v[200:203], v7, s[8:11], s45 offen
    s_waitcnt lgkmcnt(8)
    v_mfma_f32_32x32x16_bf16 v[144:159], v[48:51], v[212:215], v[144:159]
    ds_read_b64_tr_b16 v[40:41], v26 offset:128
    ds_read_b64_tr_b16 v[42:43], v26 offset:1024
    s_add_u32 s45, s44, 17408
    buffer_load_dwordx4 v[204:207], v7, s[8:11], s45 offen
    v_mfma_f32_32x32x16_bf16 v[160:175], v[52:55], v[212:215], v[160:175]
    ds_read_b64_tr_b16 v[44:45], v26 offset:160
    ds_read_b64_tr_b16 v[46:47], v26 offset:1056
    s_waitcnt lgkmcnt(8)
    v_mfma_f32_32x32x16_bf16 v[64:79], v[56:59], v[176:179], v[64:79]
    ds_read_b64_tr_b16 v[48:49], v26 offset:192
    ds_read_b64_tr_b16 v[50:51], v26 offset:1088
    v_mfma_f32_32x32x16_bf16 v[80:95], v[60:63], v[176:179], v[80:95]
    ds_read_b64_tr_b16 v[52:53], v26 offset:3584
    ds_read_b64_tr_b16 v[54:55], v26 offset:4480
    s_waitcnt lgkmcnt(8)
    v_mfma_f32_32x32x16_bf16 v[96:111], v[32:35], v[176:179], v[96:111]
    ds_read_b64_tr_b16 v[56:57], v26 offset:3616
    ds_read_b64_tr_b16 v[58:59], v26 offset:4512
    v_mfma_f32_32x32x16_bf16 v[112:127], v[36:39], v[176:179], v[112:127]
    ds_read_b64_tr_b16 v[60:61], v26 offset:3648
    ds_read_b64_tr_b16 v[62:63], v26 offset:4544
    s_waitcnt lgkmcnt(8)
    v_mfma_f32_32x32x16_bf16 v[128:143], v[40:43], v[176:179], v[128:143]
    ds_read_b64_tr_b16 v[32:33], v26 offset:3680
    ds_read_b64_tr_b16 v[34:35], v26 offset:4576
    v_mfma_f32_32x32x16_bf16 v[144:159], v[44:47], v[176:179], v[144:159]
    ds_read_b64_tr_b16 v[36:37], v26 offset:3712
    ds_read_b64_tr_b16 v[38:39], v26 offset:4608
    s_waitcnt lgkmcnt(8)
    v_mfma_f32_32x32x16_bf16 v[160:175], v[48:51], v[176:179], v[160:175]
    ds_read_b64_tr_b16 v[40:41], v26 offset:3744
    ds_read_b64_tr_b16 v[42:43], v26 offset:4640
    s_waitcnt vmcnt(12)
    s_barrier
    v_mfma_f32_32x32x16_bf16 v[64:79], v[52:55], v[180:183], v[64:79]
    ds_read_b64_tr_b16 v[44:45], v26 offset:3776
    ds_read_b64_tr_b16 v[46:47], v26 offset:4672
    s_mov_b32 s41, 1032192
    s_add_u32 s42, s40, 57856
    s_mov_b32 m0, s42
    s_nop 0
    buffer_load_dwordx4 v8, s[12:15], s41 offen lds
    s_waitcnt lgkmcnt(8)
    v_mfma_f32_32x32x16_bf16 v[80:95], v[56:59], v[180:183], v[80:95]
    ds_read_b64_tr_b16 v[48:49], v26 offset:14464
    ds_read_b64_tr_b16 v[50:51], v26 offset:15360
    s_mov_b32 s41, 1032192
    s_add_u32 s42, s40, 58880
    s_mov_b32 m0, s42
    s_nop 0
    buffer_load_dwordx4 v9, s[12:15], s41 offen lds
    v_mfma_f32_32x32x16_bf16 v[96:111], v[60:63], v[180:183], v[96:111]
    ds_read_b64_tr_b16 v[52:53], v26 offset:14496
    ds_read_b64_tr_b16 v[54:55], v26 offset:15392
    s_mov_b32 s41, 1032192
    s_add_u32 s42, s40, 59904
    s_mov_b32 m0, s42
    s_nop 0
    buffer_load_dwordx4 v10, s[12:15], s41 offen lds
    s_waitcnt lgkmcnt(8)
    v_mfma_f32_32x32x16_bf16 v[112:127], v[32:35], v[180:183], v[112:127]
    ds_read_b64_tr_b16 v[56:57], v26 offset:14528
    ds_read_b64_tr_b16 v[58:59], v26 offset:15424
    s_mov_b32 s41, 1032192
    s_add_u32 s42, s40, s52
    s_add_u32 s42, s42, 57856
    s_mov_b32 m0, s42
    s_nop 0
    buffer_load_dwordx4 v11, s[12:15], s41 offen lds
    v_mfma_f32_32x32x16_bf16 v[128:143], v[36:39], v[180:183], v[128:143]
    ds_read_b64_tr_b16 v[60:61], v26 offset:14560
    ds_read_b64_tr_b16 v[62:63], v26 offset:15456
    s_add_u32 s45, s44, 18432
    buffer_load_dwordx4 v[208:211], v7, s[8:11], s45 offen
    s_waitcnt lgkmcnt(8)
    v_mfma_f32_32x32x16_bf16 v[144:159], v[40:43], v[180:183], v[144:159]
    ds_read_b64_tr_b16 v[32:33], v26 offset:14592
    ds_read_b64_tr_b16 v[34:35], v26 offset:15488
    s_add_u32 s45, s44, 19456
    buffer_load_dwordx4 v[212:215], v7, s[8:11], s45 offen
    v_mfma_f32_32x32x16_bf16 v[160:175], v[44:47], v[180:183], v[160:175]
    ds_read_b64_tr_b16 v[36:37], v26 offset:14624
    ds_read_b64_tr_b16 v[38:39], v26 offset:15520
    s_waitcnt lgkmcnt(8)
    v_mfma_f32_32x32x16_bf16 v[64:79], v[48:51], v[184:187], v[64:79]
    ds_read_b64_tr_b16 v[40:41], v26 offset:14656
    ds_read_b64_tr_b16 v[42:43], v26 offset:15552
    v_mfma_f32_32x32x16_bf16 v[80:95], v[52:55], v[184:187], v[80:95]
    ds_read_b64_tr_b16 v[44:45], v26 offset:18048
    ds_read_b64_tr_b16 v[46:47], v26 offset:18944
    s_waitcnt lgkmcnt(8)
    v_mfma_f32_32x32x16_bf16 v[96:111], v[56:59], v[184:187], v[96:111]
    ds_read_b64_tr_b16 v[48:49], v26 offset:18080
    ds_read_b64_tr_b16 v[50:51], v26 offset:18976
    v_mfma_f32_32x32x16_bf16 v[112:127], v[60:63], v[184:187], v[112:127]
    ds_read_b64_tr_b16 v[52:53], v26 offset:18112
    ds_read_b64_tr_b16 v[54:55], v26 offset:19008
    s_waitcnt lgkmcnt(8)
    v_mfma_f32_32x32x16_bf16 v[128:143], v[32:35], v[184:187], v[128:143]
    ds_read_b64_tr_b16 v[56:57], v26 offset:18144
    ds_read_b64_tr_b16 v[58:59], v26 offset:19040
    v_mfma_f32_32x32x16_bf16 v[144:159], v[36:39], v[184:187], v[144:159]
    ds_read_b64_tr_b16 v[60:61], v26 offset:18176
    ds_read_b64_tr_b16 v[62:63], v26 offset:19072
    s_waitcnt lgkmcnt(8)
    v_mfma_f32_32x32x16_bf16 v[160:175], v[40:43], v[184:187], v[160:175]
    ds_read_b64_tr_b16 v[32:33], v26 offset:18208
    ds_read_b64_tr_b16 v[34:35], v26 offset:19104
    s_waitcnt vmcnt(12)
    s_barrier
    v_mfma_f32_32x32x16_bf16 v[64:79], v[44:47], v[188:191], v[64:79]
    ds_read_b64_tr_b16 v[36:37], v26 offset:18240
    ds_read_b64_tr_b16 v[38:39], v26 offset:19136
    s_mov_b32 s41, 1146880
    s_add_u32 s42, s40, 0
    s_mov_b32 m0, s42
    s_nop 0
    buffer_load_dwordx4 v8, s[12:15], s41 offen lds
    s_waitcnt lgkmcnt(8)
    v_mfma_f32_32x32x16_bf16 v[80:95], v[48:51], v[188:191], v[80:95]
    ds_read_b64_tr_b16 v[40:41], v26 offset:28928
    ds_read_b64_tr_b16 v[42:43], v26 offset:29824
    s_mov_b32 s41, 1146880
    s_add_u32 s42, s40, 1024
    s_mov_b32 m0, s42
    s_nop 0
    buffer_load_dwordx4 v9, s[12:15], s41 offen lds
    v_mfma_f32_32x32x16_bf16 v[96:111], v[52:55], v[188:191], v[96:111]
    ds_read_b64_tr_b16 v[44:45], v26 offset:28960
    ds_read_b64_tr_b16 v[46:47], v26 offset:29856
    s_mov_b32 s41, 1146880
    s_add_u32 s42, s40, 2048
    s_mov_b32 m0, s42
    s_nop 0
    buffer_load_dwordx4 v10, s[12:15], s41 offen lds
    s_waitcnt lgkmcnt(8)
    v_mfma_f32_32x32x16_bf16 v[112:127], v[56:59], v[188:191], v[112:127]
    ds_read_b64_tr_b16 v[48:49], v26 offset:28992
    ds_read_b64_tr_b16 v[50:51], v26 offset:29888
    s_mov_b32 s41, 1146880
    s_add_u32 s42, s40, s52
    s_add_u32 s42, s42, 0
    s_mov_b32 m0, s42
    s_nop 0
    buffer_load_dwordx4 v11, s[12:15], s41 offen lds
    v_mfma_f32_32x32x16_bf16 v[128:143], v[60:63], v[188:191], v[128:143]
    ds_read_b64_tr_b16 v[52:53], v26 offset:29024
    ds_read_b64_tr_b16 v[54:55], v26 offset:29920
    s_add_u32 s45, s44, 20480
    buffer_load_dwordx4 v[176:179], v7, s[8:11], s45 offen
    s_waitcnt lgkmcnt(8)
    v_mfma_f32_32x32x16_bf16 v[144:159], v[32:35], v[188:191], v[144:159]
    ds_read_b64_tr_b16 v[56:57], v26 offset:29056
    ds_read_b64_tr_b16 v[58:59], v26 offset:29952
    s_add_u32 s45, s44, 21504
    buffer_load_dwordx4 v[180:183], v7, s[8:11], s45 offen
    v_mfma_f32_32x32x16_bf16 v[160:175], v[36:39], v[188:191], v[160:175]
    ds_read_b64_tr_b16 v[60:61], v26 offset:29088
    ds_read_b64_tr_b16 v[62:63], v26 offset:29984
    s_waitcnt lgkmcnt(8)
    v_mfma_f32_32x32x16_bf16 v[64:79], v[40:43], v[192:195], v[64:79]
    ds_read_b64_tr_b16 v[32:33], v26 offset:29120
    ds_read_b64_tr_b16 v[34:35], v26 offset:30016
    v_mfma_f32_32x32x16_bf16 v[80:95], v[44:47], v[192:195], v[80:95]
    ds_read_b64_tr_b16 v[36:37], v26 offset:32512
    ds_read_b64_tr_b16 v[38:39], v26 offset:33408
    s_waitcnt lgkmcnt(8)
    v_mfma_f32_32x32x16_bf16 v[96:111], v[48:51], v[192:195], v[96:111]
    ds_read_b64_tr_b16 v[40:41], v26 offset:32544
    ds_read_b64_tr_b16 v[42:43], v26 offset:33440
    v_mfma_f32_32x32x16_bf16 v[112:127], v[52:55], v[192:195], v[112:127]
    ds_read_b64_tr_b16 v[44:45], v26 offset:32576
    ds_read_b64_tr_b16 v[46:47], v26 offset:33472
    s_waitcnt lgkmcnt(8)
    v_mfma_f32_32x32x16_bf16 v[128:143], v[56:59], v[192:195], v[128:143]
    ds_read_b64_tr_b16 v[48:49], v26 offset:32608
    ds_read_b64_tr_b16 v[50:51], v26 offset:33504
    v_mfma_f32_32x32x16_bf16 v[144:159], v[60:63], v[192:195], v[144:159]
    ds_read_b64_tr_b16 v[52:53], v26 offset:32640
    ds_read_b64_tr_b16 v[54:55], v26 offset:33536
    s_waitcnt lgkmcnt(8)
    v_mfma_f32_32x32x16_bf16 v[160:175], v[32:35], v[192:195], v[160:175]
    ds_read_b64_tr_b16 v[56:57], v26 offset:32672
    ds_read_b64_tr_b16 v[58:59], v26 offset:33568
    s_waitcnt vmcnt(12)
    s_barrier
    v_mfma_f32_32x32x16_bf16 v[64:79], v[36:39], v[196:199], v[64:79]
    ds_read_b64_tr_b16 v[60:61], v26 offset:32704
    ds_read_b64_tr_b16 v[62:63], v26 offset:33600
    s_mov_b32 s41, 1261568
    s_add_u32 s42, s40, 14464
    s_mov_b32 m0, s42
    s_nop 0
    buffer_load_dwordx4 v8, s[12:15], s41 offen lds
    s_waitcnt lgkmcnt(8)
    v_mfma_f32_32x32x16_bf16 v[80:95], v[40:43], v[196:199], v[80:95]
    ds_read_b64_tr_b16 v[32:33], v27 offset:0
    ds_read_b64_tr_b16 v[34:35], v27 offset:896
    s_mov_b32 s41, 1261568
    s_add_u32 s42, s40, 15488
    s_mov_b32 m0, s42
    s_nop 0
    buffer_load_dwordx4 v9, s[12:15], s41 offen lds
    v_mfma_f32_32x32x16_bf16 v[96:111], v[44:47], v[196:199], v[96:111]
    ds_read_b64_tr_b16 v[36:37], v27 offset:32
    ds_read_b64_tr_b16 v[38:39], v27 offset:928
    s_mov_b32 s41, 1261568
    s_add_u32 s42, s40, 16512
    s_mov_b32 m0, s42
    s_nop 0
    buffer_load_dwordx4 v10, s[12:15], s41 offen lds
    s_waitcnt lgkmcnt(8)
    v_mfma_f32_32x32x16_bf16 v[112:127], v[48:51], v[196:199], v[112:127]
    ds_read_b64_tr_b16 v[40:41], v27 offset:64
    ds_read_b64_tr_b16 v[42:43], v27 offset:960
    s_mov_b32 s41, 1261568
    s_add_u32 s42, s40, s52
    s_add_u32 s42, s42, 14464
    s_mov_b32 m0, s42
    s_nop 0
    buffer_load_dwordx4 v11, s[12:15], s41 offen lds
    v_mfma_f32_32x32x16_bf16 v[128:143], v[52:55], v[196:199], v[128:143]
    ds_read_b64_tr_b16 v[44:45], v27 offset:96
    ds_read_b64_tr_b16 v[46:47], v27 offset:992
    s_add_u32 s45, s44, 22528
    buffer_load_dwordx4 v[184:187], v7, s[8:11], s45 offen
    s_waitcnt lgkmcnt(8)
    v_mfma_f32_32x32x16_bf16 v[144:159], v[56:59], v[196:199], v[144:159]
    ds_read_b64_tr_b16 v[48:49], v27 offset:128
    ds_read_b64_tr_b16 v[50:51], v27 offset:1024
    s_add_u32 s45, s44, 23552
    buffer_load_dwordx4 v[188:191], v7, s[8:11], s45 offen
    v_mfma_f32_32x32x16_bf16 v[160:175], v[60:63], v[196:199], v[160:175]
    ds_read_b64_tr_b16 v[52:53], v27 offset:160
    ds_read_b64_tr_b16 v[54:55], v27 offset:1056
    s_waitcnt lgkmcnt(8)
    v_mfma_f32_32x32x16_bf16 v[64:79], v[32:35], v[200:203], v[64:79]
    ds_read_b64_tr_b16 v[56:57], v27 offset:192
    ds_read_b64_tr_b16 v[58:59], v27 offset:1088
    v_mfma_f32_32x32x16_bf16 v[80:95], v[36:39], v[200:203], v[80:95]
    ds_read_b64_tr_b16 v[60:61], v27 offset:3584
    ds_read_b64_tr_b16 v[62:63], v27 offset:4480
    s_waitcnt lgkmcnt(8)
    v_mfma_f32_32x32x16_bf16 v[96:111], v[40:43], v[200:203], v[96:111]
    ds_read_b64_tr_b16 v[32:33], v27 offset:3616
    ds_read_b64_tr_b16 v[34:35], v27 offset:4512
    v_mfma_f32_32x32x16_bf16 v[112:127], v[44:47], v[200:203], v[112:127]
    ds_read_b64_tr_b16 v[36:37], v27 offset:3648
    ds_read_b64_tr_b16 v[38:39], v27 offset:4544
    s_waitcnt lgkmcnt(8)
    v_mfma_f32_32x32x16_bf16 v[128:143], v[48:51], v[200:203], v[128:143]
    ds_read_b64_tr_b16 v[40:41], v27 offset:3680
    ds_read_b64_tr_b16 v[42:43], v27 offset:4576
    v_mfma_f32_32x32x16_bf16 v[144:159], v[52:55], v[200:203], v[144:159]
    ds_read_b64_tr_b16 v[44:45], v27 offset:3712
    ds_read_b64_tr_b16 v[46:47], v27 offset:4608
    s_waitcnt lgkmcnt(8)
    v_mfma_f32_32x32x16_bf16 v[160:175], v[56:59], v[200:203], v[160:175]
    ds_read_b64_tr_b16 v[48:49], v27 offset:3744
    ds_read_b64_tr_b16 v[50:51], v27 offset:4640
    s_waitcnt vmcnt(12)
    s_barrier
    v_mfma_f32_32x32x16_bf16 v[64:79], v[60:63], v[204:207], v[64:79]
    ds_read_b64_tr_b16 v[52:53], v27 offset:3776
    ds_read_b64_tr_b16 v[54:55], v27 offset:4672
    s_mov_b32 s41, 1376256
    s_add_u32 s42, s40, 28928
    s_mov_b32 m0, s42
    s_nop 0
    buffer_load_dwordx4 v8, s[12:15], s41 offen lds
    s_waitcnt lgkmcnt(8)
    v_mfma_f32_32x32x16_bf16 v[80:95], v[32:35], v[204:207], v[80:95]
    ds_read_b64_tr_b16 v[56:57], v27 offset:14464
    ds_read_b64_tr_b16 v[58:59], v27 offset:15360
    s_mov_b32 s41, 1376256
    s_add_u32 s42, s40, 29952
    s_mov_b32 m0, s42
    s_nop 0
    buffer_load_dwordx4 v9, s[12:15], s41 offen lds
    v_mfma_f32_32x32x16_bf16 v[96:111], v[36:39], v[204:207], v[96:111]
    ds_read_b64_tr_b16 v[60:61], v27 offset:14496
    ds_read_b64_tr_b16 v[62:63], v27 offset:15392
    s_mov_b32 s41, 1376256
    s_add_u32 s42, s40, 30976
    s_mov_b32 m0, s42
    s_nop 0
    buffer_load_dwordx4 v10, s[12:15], s41 offen lds
    s_waitcnt lgkmcnt(8)
    v_mfma_f32_32x32x16_bf16 v[112:127], v[40:43], v[204:207], v[112:127]
    ds_read_b64_tr_b16 v[32:33], v27 offset:14528
    ds_read_b64_tr_b16 v[34:35], v27 offset:15424
    s_mov_b32 s41, 1376256
    s_add_u32 s42, s40, s52
    s_add_u32 s42, s42, 28928
    s_mov_b32 m0, s42
    s_nop 0
    buffer_load_dwordx4 v11, s[12:15], s41 offen lds
    v_mfma_f32_32x32x16_bf16 v[128:143], v[44:47], v[204:207], v[128:143]
    ds_read_b64_tr_b16 v[36:37], v27 offset:14560
    ds_read_b64_tr_b16 v[38:39], v27 offset:15456
    s_add_u32 s45, s44, 24576
    buffer_load_dwordx4 v[192:195], v7, s[8:11], s45 offen
    s_waitcnt lgkmcnt(8)
    v_mfma_f32_32x32x16_bf16 v[144:159], v[48:51], v[204:207], v[144:159]
    ds_read_b64_tr_b16 v[40:41], v27 offset:14592
    ds_read_b64_tr_b16 v[42:43], v27 offset:15488
    s_add_u32 s45, s44, 25600
    buffer_load_dwordx4 v[196:199], v7, s[8:11], s45 offen
    v_mfma_f32_32x32x16_bf16 v[160:175], v[52:55], v[204:207], v[160:175]
    ds_read_b64_tr_b16 v[44:45], v27 offset:14624
    ds_read_b64_tr_b16 v[46:47], v27 offset:15520
    s_waitcnt lgkmcnt(8)
    v_mfma_f32_32x32x16_bf16 v[64:79], v[56:59], v[208:211], v[64:79]
    ds_read_b64_tr_b16 v[48:49], v27 offset:14656
    ds_read_b64_tr_b16 v[50:51], v27 offset:15552
    v_mfma_f32_32x32x16_bf16 v[80:95], v[60:63], v[208:211], v[80:95]
    ds_read_b64_tr_b16 v[52:53], v27 offset:18048
    ds_read_b64_tr_b16 v[54:55], v27 offset:18944
    s_waitcnt lgkmcnt(8)
    v_mfma_f32_32x32x16_bf16 v[96:111], v[32:35], v[208:211], v[96:111]
    ds_read_b64_tr_b16 v[56:57], v27 offset:18080
    ds_read_b64_tr_b16 v[58:59], v27 offset:18976
    v_mfma_f32_32x32x16_bf16 v[112:127], v[36:39], v[208:211], v[112:127]
    ds_read_b64_tr_b16 v[60:61], v27 offset:18112
    ds_read_b64_tr_b16 v[62:63], v27 offset:19008
    s_waitcnt lgkmcnt(8)
    v_mfma_f32_32x32x16_bf16 v[128:143], v[40:43], v[208:211], v[128:143]
    ds_read_b64_tr_b16 v[32:33], v27 offset:18144
    ds_read_b64_tr_b16 v[34:35], v27 offset:19040
    v_mfma_f32_32x32x16_bf16 v[144:159], v[44:47], v[208:211], v[144:159]
    ds_read_b64_tr_b16 v[36:37], v27 offset:18176
    ds_read_b64_tr_b16 v[38:39], v27 offset:19072
    s_waitcnt lgkmcnt(8)
    v_mfma_f32_32x32x16_bf16 v[160:175], v[48:51], v[208:211], v[160:175]
    ds_read_b64_tr_b16 v[40:41], v27 offset:18208
    ds_read_b64_tr_b16 v[42:43], v27 offset:19104
    s_waitcnt vmcnt(12)
    s_barrier
    v_mfma_f32_32x32x16_bf16 v[64:79], v[52:55], v[212:215], v[64:79]
    ds_read_b64_tr_b16 v[44:45], v27 offset:18240
    ds_read_b64_tr_b16 v[46:47], v27 offset:19136
    s_mov_b32 s41, 1490944
    s_add_u32 s42, s40, 43392
    s_mov_b32 m0, s42
    s_nop 0
    buffer_load_dwordx4 v8, s[12:15], s41 offen lds
    s_waitcnt lgkmcnt(8)
    v_mfma_f32_32x32x16_bf16 v[80:95], v[56:59], v[212:215], v[80:95]
    ds_read_b64_tr_b16 v[48:49], v26 offset:0
    ds_read_b64_tr_b16 v[50:51], v26 offset:896
    s_mov_b32 s41, 1490944
    s_add_u32 s42, s40, 44416
    s_mov_b32 m0, s42
    s_nop 0
    buffer_load_dwordx4 v9, s[12:15], s41 offen lds
    v_mfma_f32_32x32x16_bf16 v[96:111], v[60:63], v[212:215], v[96:111]
    ds_read_b64_tr_b16 v[52:53], v26 offset:32
    ds_read_b64_tr_b16 v[54:55], v26 offset:928
    s_mov_b32 s41, 1490944
    s_add_u32 s42, s40, 45440
    s_mov_b32 m0, s42
    s_nop 0
    buffer_load_dwordx4 v10, s[12:15], s41 offen lds
    s_waitcnt lgkmcnt(8)
    v_mfma_f32_32x32x16_bf16 v[112:127], v[32:35], v[212:215], v[112:127]
    ds_read_b64_tr_b16 v[56:57], v26 offset:64
    ds_read_b64_tr_b16 v[58:59], v26 offset:960
    s_mov_b32 s41, 1490944
    s_add_u32 s42, s40, s52
    s_add_u32 s42, s42, 43392
    s_mov_b32 m0, s42
    s_nop 0
    buffer_load_dwordx4 v11, s[12:15], s41 offen lds
    v_mfma_f32_32x32x16_bf16 v[128:143], v[36:39], v[212:215], v[128:143]
    ds_read_b64_tr_b16 v[60:61], v26 offset:96
    ds_read_b64_tr_b16 v[62:63], v26 offset:992
    s_add_u32 s45, s44, 26624
    buffer_load_dwordx4 v[200:203], v7, s[8:11], s45 offen
    s_waitcnt lgkmcnt(8)
    v_mfma_f32_32x32x16_bf16 v[144:159], v[40:43], v[212:215], v[144:159]
    ds_read_b64_tr_b16 v[32:33], v26 offset:128
    ds_read_b64_tr_b16 v[34:35], v26 offset:1024
    s_add_u32 s45, s44, 27648
    buffer_load_dwordx4 v[204:207], v7, s[8:11], s45 offen
    v_mfma_f32_32x32x16_bf16 v[160:175], v[44:47], v[212:215], v[160:175]
    ds_read_b64_tr_b16 v[36:37], v26 offset:160
    ds_read_b64_tr_b16 v[38:39], v26 offset:1056
    s_waitcnt lgkmcnt(8)
    v_mfma_f32_32x32x16_bf16 v[64:79], v[48:51], v[176:179], v[64:79]
    ds_read_b64_tr_b16 v[40:41], v26 offset:192
    ds_read_b64_tr_b16 v[42:43], v26 offset:1088
    v_mfma_f32_32x32x16_bf16 v[80:95], v[52:55], v[176:179], v[80:95]
    ds_read_b64_tr_b16 v[44:45], v26 offset:3584
    ds_read_b64_tr_b16 v[46:47], v26 offset:4480
    s_waitcnt lgkmcnt(8)
    v_mfma_f32_32x32x16_bf16 v[96:111], v[56:59], v[176:179], v[96:111]
    ds_read_b64_tr_b16 v[48:49], v26 offset:3616
    ds_read_b64_tr_b16 v[50:51], v26 offset:4512
    v_mfma_f32_32x32x16_bf16 v[112:127], v[60:63], v[176:179], v[112:127]
    ds_read_b64_tr_b16 v[52:53], v26 offset:3648
    ds_read_b64_tr_b16 v[54:55], v26 offset:4544
    s_waitcnt lgkmcnt(8)
    v_mfma_f32_32x32x16_bf16 v[128:143], v[32:35], v[176:179], v[128:143]
    ds_read_b64_tr_b16 v[56:57], v26 offset:3680
    ds_read_b64_tr_b16 v[58:59], v26 offset:4576
    v_mfma_f32_32x32x16_bf16 v[144:159], v[36:39], v[176:179], v[144:159]
    ds_read_b64_tr_b16 v[60:61], v26 offset:3712
    ds_read_b64_tr_b16 v[62:63], v26 offset:4608
    s_waitcnt lgkmcnt(8)
    v_mfma_f32_32x32x16_bf16 v[160:175], v[40:43], v[176:179], v[160:175]
    ds_read_b64_tr_b16 v[32:33], v26 offset:3744
    ds_read_b64_tr_b16 v[34:35], v26 offset:4640
    s_waitcnt vmcnt(12)
    s_barrier
    v_mfma_f32_32x32x16_bf16 v[64:79], v[44:47], v[180:183], v[64:79]
    ds_read_b64_tr_b16 v[36:37], v26 offset:3776
    ds_read_b64_tr_b16 v[38:39], v26 offset:4672
    s_mov_b32 s41, 1605632
    s_add_u32 s42, s40, 57856
    s_mov_b32 m0, s42
    s_nop 0
    buffer_load_dwordx4 v8, s[12:15], s41 offen lds
    s_waitcnt lgkmcnt(8)
    v_mfma_f32_32x32x16_bf16 v[80:95], v[48:51], v[180:183], v[80:95]
    ds_read_b64_tr_b16 v[40:41], v26 offset:14464
    ds_read_b64_tr_b16 v[42:43], v26 offset:15360
    s_mov_b32 s41, 1605632
    s_add_u32 s42, s40, 58880
    s_mov_b32 m0, s42
    s_nop 0
    buffer_load_dwordx4 v9, s[12:15], s41 offen lds
    v_mfma_f32_32x32x16_bf16 v[96:111], v[52:55], v[180:183], v[96:111]
    ds_read_b64_tr_b16 v[44:45], v26 offset:14496
    ds_read_b64_tr_b16 v[46:47], v26 offset:15392
    s_mov_b32 s41, 1605632
    s_add_u32 s42, s40, 59904
    s_mov_b32 m0, s42
    s_nop 0
    buffer_load_dwordx4 v10, s[12:15], s41 offen lds
    s_waitcnt lgkmcnt(8)
    v_mfma_f32_32x32x16_bf16 v[112:127], v[56:59], v[180:183], v[112:127]
    ds_read_b64_tr_b16 v[48:49], v26 offset:14528
    ds_read_b64_tr_b16 v[50:51], v26 offset:15424
    s_mov_b32 s41, 1605632
    s_add_u32 s42, s40, s52
    s_add_u32 s42, s42, 57856
    s_mov_b32 m0, s42
    s_nop 0
    buffer_load_dwordx4 v11, s[12:15], s41 offen lds
    v_mfma_f32_32x32x16_bf16 v[128:143], v[60:63], v[180:183], v[128:143]
    ds_read_b64_tr_b16 v[52:53], v26 offset:14560
    ds_read_b64_tr_b16 v[54:55], v26 offset:15456
    s_add_u32 s45, s44, 28672
    buffer_load_dwordx4 v[208:211], v7, s[8:11], s45 offen
    s_waitcnt lgkmcnt(8)
    v_mfma_f32_32x32x16_bf16 v[144:159], v[32:35], v[180:183], v[144:159]
    ds_read_b64_tr_b16 v[56:57], v26 offset:14592
    ds_read_b64_tr_b16 v[58:59], v26 offset:15488
    s_add_u32 s45, s44, 29696
    buffer_load_dwordx4 v[212:215], v7, s[8:11], s45 offen
    v_mfma_f32_32x32x16_bf16 v[160:175], v[36:39], v[180:183], v[160:175]
    ds_read_b64_tr_b16 v[60:61], v26 offset:14624
    ds_read_b64_tr_b16 v[62:63], v26 offset:15520
    s_waitcnt lgkmcnt(8)
    v_mfma_f32_32x32x16_bf16 v[64:79], v[40:43], v[184:187], v[64:79]
    ds_read_b64_tr_b16 v[32:33], v26 offset:14656
    ds_read_b64_tr_b16 v[34:35], v26 offset:15552
    v_mfma_f32_32x32x16_bf16 v[80:95], v[44:47], v[184:187], v[80:95]
    ds_read_b64_tr_b16 v[36:37], v26 offset:18048
    ds_read_b64_tr_b16 v[38:39], v26 offset:18944
    s_waitcnt lgkmcnt(8)
    v_mfma_f32_32x32x16_bf16 v[96:111], v[48:51], v[184:187], v[96:111]
    ds_read_b64_tr_b16 v[40:41], v26 offset:18080
    ds_read_b64_tr_b16 v[42:43], v26 offset:18976
    v_mfma_f32_32x32x16_bf16 v[112:127], v[52:55], v[184:187], v[112:127]
    ds_read_b64_tr_b16 v[44:45], v26 offset:18112
    ds_read_b64_tr_b16 v[46:47], v26 offset:19008
    s_waitcnt lgkmcnt(8)
    v_mfma_f32_32x32x16_bf16 v[128:143], v[56:59], v[184:187], v[128:143]
    ds_read_b64_tr_b16 v[48:49], v26 offset:18144
    ds_read_b64_tr_b16 v[50:51], v26 offset:19040
    v_mfma_f32_32x32x16_bf16 v[144:159], v[60:63], v[184:187], v[144:159]
    ds_read_b64_tr_b16 v[52:53], v26 offset:18176
    ds_read_b64_tr_b16 v[54:55], v26 offset:19072
    s_waitcnt lgkmcnt(8)
    v_mfma_f32_32x32x16_bf16 v[160:175], v[32:35], v[184:187], v[160:175]
    ds_read_b64_tr_b16 v[56:57], v26 offset:18208
    ds_read_b64_tr_b16 v[58:59], v26 offset:19104
    s_waitcnt vmcnt(12)
    s_barrier
    v_mfma_f32_32x32x16_bf16 v[64:79], v[36:39], v[188:191], v[64:79]
    ds_read_b64_tr_b16 v[60:61], v26 offset:18240
    ds_read_b64_tr_b16 v[62:63], v26 offset:19136
    s_mov_b32 s41, 1720320
    s_add_u32 s42, s40, 0
    s_mov_b32 m0, s42
    s_nop 0
    buffer_load_dwordx4 v8, s[12:15], s41 offen lds
    s_waitcnt lgkmcnt(8)
    v_mfma_f32_32x32x16_bf16 v[80:95], v[40:43], v[188:191], v[80:95]
    ds_read_b64_tr_b16 v[32:33], v26 offset:28928
    ds_read_b64_tr_b16 v[34:35], v26 offset:29824
    s_mov_b32 s41, 1720320
    s_add_u32 s42, s40, 1024
    s_mov_b32 m0, s42
    s_nop 0
    buffer_load_dwordx4 v9, s[12:15], s41 offen lds
    v_mfma_f32_32x32x16_bf16 v[96:111], v[44:47], v[188:191], v[96:111]
    ds_read_b64_tr_b16 v[36:37], v26 offset:28960
    ds_read_b64_tr_b16 v[38:39], v26 offset:29856
    s_mov_b32 s41, 1720320
    s_add_u32 s42, s40, 2048
    s_mov_b32 m0, s42
    s_nop 0
    buffer_load_dwordx4 v10, s[12:15], s41 offen lds
    s_waitcnt lgkmcnt(8)
    v_mfma_f32_32x32x16_bf16 v[112:127], v[48:51], v[188:191], v[112:127]
    ds_read_b64_tr_b16 v[40:41], v26 offset:28992
    ds_read_b64_tr_b16 v[42:43], v26 offset:29888
    s_mov_b32 s41, 1720320
    s_add_u32 s42, s40, s52
    s_add_u32 s42, s42, 0
    s_mov_b32 m0, s42
    s_nop 0
    buffer_load_dwordx4 v11, s[12:15], s41 offen lds
    v_mfma_f32_32x32x16_bf16 v[128:143], v[52:55], v[188:191], v[128:143]
    ds_read_b64_tr_b16 v[44:45], v26 offset:29024
    ds_read_b64_tr_b16 v[46:47], v26 offset:29920
    s_add_u32 s45, s44, 30720
    buffer_load_dwordx4 v[176:179], v7, s[8:11], s45 offen
    s_waitcnt lgkmcnt(8)
    v_mfma_f32_32x32x16_bf16 v[144:159], v[56:59], v[188:191], v[144:159]
    ds_read_b64_tr_b16 v[48:49], v26 offset:29056
    ds_read_b64_tr_b16 v[50:51], v26 offset:29952
    s_add_u32 s45, s44, 31744
    buffer_load_dwordx4 v[180:183], v7, s[8:11], s45 offen
    v_mfma_f32_32x32x16_bf16 v[160:175], v[60:63], v[188:191], v[160:175]
    ds_read_b64_tr_b16 v[52:53], v26 offset:29088
    ds_read_b64_tr_b16 v[54:55], v26 offset:29984
    s_waitcnt lgkmcnt(8)
    v_mfma_f32_32x32x16_bf16 v[64:79], v[32:35], v[192:195], v[64:79]
    ds_read_b64_tr_b16 v[56:57], v26 offset:29120
    ds_read_b64_tr_b16 v[58:59], v26 offset:30016
    v_mfma_f32_32x32x16_bf16 v[80:95], v[36:39], v[192:195], v[80:95]
    ds_read_b64_tr_b16 v[60:61], v26 offset:32512
    ds_read_b64_tr_b16 v[62:63], v26 offset:33408
    s_waitcnt lgkmcnt(8)
    v_mfma_f32_32x32x16_bf16 v[96:111], v[40:43], v[192:195], v[96:111]
    ds_read_b64_tr_b16 v[32:33], v26 offset:32544
    ds_read_b64_tr_b16 v[34:35], v26 offset:33440
    v_mfma_f32_32x32x16_bf16 v[112:127], v[44:47], v[192:195], v[112:127]
    ds_read_b64_tr_b16 v[36:37], v26 offset:32576
    ds_read_b64_tr_b16 v[38:39], v26 offset:33472
    s_waitcnt lgkmcnt(8)
    v_mfma_f32_32x32x16_bf16 v[128:143], v[48:51], v[192:195], v[128:143]
    ds_read_b64_tr_b16 v[40:41], v26 offset:32608
    ds_read_b64_tr_b16 v[42:43], v26 offset:33504
    v_mfma_f32_32x32x16_bf16 v[144:159], v[52:55], v[192:195], v[144:159]
    ds_read_b64_tr_b16 v[44:45], v26 offset:32640
    ds_read_b64_tr_b16 v[46:47], v26 offset:33536
    s_waitcnt lgkmcnt(8)
    v_mfma_f32_32x32x16_bf16 v[160:175], v[56:59], v[192:195], v[160:175]
    ds_read_b64_tr_b16 v[48:49], v26 offset:32672
    ds_read_b64_tr_b16 v[50:51], v26 offset:33568
    s_waitcnt vmcnt(12)
    s_barrier
    v_mfma_f32_32x32x16_bf16 v[64:79], v[60:63], v[196:199], v[64:79]
    ds_read_b64_tr_b16 v[52:53], v26 offset:32704
    ds_read_b64_tr_b16 v[54:55], v26 offset:33600
    s_waitcnt lgkmcnt(8)
    v_mfma_f32_32x32x16_bf16 v[80:95], v[32:35], v[196:199], v[80:95]
    ds_read_b64_tr_b16 v[56:57], v27 offset:0
    ds_read_b64_tr_b16 v[58:59], v27 offset:896
    v_mfma_f32_32x32x16_bf16 v[96:111], v[36:39], v[196:199], v[96:111]
    ds_read_b64_tr_b16 v[60:61], v27 offset:32
    ds_read_b64_tr_b16 v[62:63], v27 offset:928
    s_waitcnt lgkmcnt(8)
    v_mfma_f32_32x32x16_bf16 v[112:127], v[40:43], v[196:199], v[112:127]
    ds_read_b64_tr_b16 v[32:33], v27 offset:64
    ds_read_b64_tr_b16 v[34:35], v27 offset:960
    v_mfma_f32_32x32x16_bf16 v[128:143], v[44:47], v[196:199], v[128:143]
    ds_read_b64_tr_b16 v[36:37], v27 offset:96
    ds_read_b64_tr_b16 v[38:39], v27 offset:992
    s_waitcnt lgkmcnt(8)
    v_mfma_f32_32x32x16_bf16 v[144:159], v[48:51], v[196:199], v[144:159]
    ds_read_b64_tr_b16 v[40:41], v27 offset:128
    ds_read_b64_tr_b16 v[42:43], v27 offset:1024
    v_mfma_f32_32x32x16_bf16 v[160:175], v[52:55], v[196:199], v[160:175]
    ds_read_b64_tr_b16 v[44:45], v27 offset:160
    ds_read_b64_tr_b16 v[46:47], v27 offset:1056
    s_waitcnt lgkmcnt(8)
    v_mfma_f32_32x32x16_bf16 v[64:79], v[56:59], v[200:203], v[64:79]
    ds_read_b64_tr_b16 v[48:49], v27 offset:192
    ds_read_b64_tr_b16 v[50:51], v27 offset:1088
    v_mfma_f32_32x32x16_bf16 v[80:95], v[60:63], v[200:203], v[80:95]
    ds_read_b64_tr_b16 v[52:53], v27 offset:3584
    ds_read_b64_tr_b16 v[54:55], v27 offset:4480
    s_lshl_b32 s46, s2, 13
    s_lshl_b32 s47, s16, 11
    s_add_u32 s46, s46, s47
    buffer_load_dwordx4 v[224:227], v7, s[56:59], s46 offen offset:0
    s_waitcnt lgkmcnt(8)
    v_mfma_f32_32x32x16_bf16 v[96:111], v[32:35], v[200:203], v[96:111]
    ds_read_b64_tr_b16 v[56:57], v27 offset:3616
    ds_read_b64_tr_b16 v[58:59], v27 offset:4512
    s_lshl_b32 s46, s2, 13
    s_lshl_b32 s47, s16, 11
    s_add_u32 s46, s46, s47
    buffer_load_dwordx4 v[224:227], v7, s[56:59], s46 offen offset:1024
    v_mfma_f32_32x32x16_bf16 v[112:127], v[36:39], v[200:203], v[112:127]
    ds_read_b64_tr_b16 v[60:61], v27 offset:3648
    ds_read_b64_tr_b16 v[62:63], v27 offset:4544
    s_waitcnt lgkmcnt(8)
    v_mfma_f32_32x32x16_bf16 v[128:143], v[40:43], v[200:203], v[128:143]
    ds_read_b64_tr_b16 v[32:33], v27 offset:3680
    ds_read_b64_tr_b16 v[34:35], v27 offset:4576
    v_mfma_f32_32x32x16_bf16 v[144:159], v[44:47], v[200:203], v[144:159]
    ds_read_b64_tr_b16 v[36:37], v27 offset:3712
    ds_read_b64_tr_b16 v[38:39], v27 offset:4608
    s_waitcnt lgkmcnt(8)
    v_mfma_f32_32x32x16_bf16 v[160:175], v[48:51], v[200:203], v[160:175]
    ds_read_b64_tr_b16 v[40:41], v27 offset:3744
    ds_read_b64_tr_b16 v[42:43], v27 offset:4640
    s_waitcnt vmcnt(8)
    s_barrier
    v_mfma_f32_32x32x16_bf16 v[64:79], v[52:55], v[204:207], v[64:79]
    ds_read_b64_tr_b16 v[44:45], v27 offset:3776
    ds_read_b64_tr_b16 v[46:47], v27 offset:4672
    s_waitcnt lgkmcnt(8)
    v_mfma_f32_32x32x16_bf16 v[80:95], v[56:59], v[204:207], v[80:95]
    ds_read_b64_tr_b16 v[48:49], v27 offset:14464
    ds_read_b64_tr_b16 v[50:51], v27 offset:15360
    v_mfma_f32_32x32x16_bf16 v[96:111], v[60:63], v[204:207], v[96:111]
    ds_read_b64_tr_b16 v[52:53], v27 offset:14496
    ds_read_b64_tr_b16 v[54:55], v27 offset:15392
    s_waitcnt lgkmcnt(8)
    v_mfma_f32_32x32x16_bf16 v[112:127], v[32:35], v[204:207], v[112:127]
    ds_read_b64_tr_b16 v[56:57], v27 offset:14528
    ds_read_b64_tr_b16 v[58:59], v27 offset:15424
    v_mfma_f32_32x32x16_bf16 v[128:143], v[36:39], v[204:207], v[128:143]
    ds_read_b64_tr_b16 v[60:61], v27 offset:14560
    ds_read_b64_tr_b16 v[62:63], v27 offset:15456
    s_waitcnt lgkmcnt(8)
    v_mfma_f32_32x32x16_bf16 v[144:159], v[40:43], v[204:207], v[144:159]
    ds_read_b64_tr_b16 v[32:33], v27 offset:14592
    ds_read_b64_tr_b16 v[34:35], v27 offset:15488
    v_mfma_f32_32x32x16_bf16 v[160:175], v[44:47], v[204:207], v[160:175]
    ds_read_b64_tr_b16 v[36:37], v27 offset:14624
    ds_read_b64_tr_b16 v[38:39], v27 offset:15520
    s_waitcnt lgkmcnt(8)
    v_mfma_f32_32x32x16_bf16 v[64:79], v[48:51], v[208:211], v[64:79]
    ds_read_b64_tr_b16 v[40:41], v27 offset:14656
    ds_read_b64_tr_b16 v[42:43], v27 offset:15552
    v_mfma_f32_32x32x16_bf16 v[80:95], v[52:55], v[208:211], v[80:95]
    ds_read_b64_tr_b16 v[44:45], v27 offset:18048
    ds_read_b64_tr_b16 v[46:47], v27 offset:18944
    s_waitcnt lgkmcnt(8)
    v_mfma_f32_32x32x16_bf16 v[96:111], v[56:59], v[208:211], v[96:111]
    ds_read_b64_tr_b16 v[48:49], v27 offset:18080
    ds_read_b64_tr_b16 v[50:51], v27 offset:18976
    v_mfma_f32_32x32x16_bf16 v[112:127], v[60:63], v[208:211], v[112:127]
    ds_read_b64_tr_b16 v[52:53], v27 offset:18112
    ds_read_b64_tr_b16 v[54:55], v27 offset:19008
    s_waitcnt lgkmcnt(8)
    v_mfma_f32_32x32x16_bf16 v[128:143], v[32:35], v[208:211], v[128:143]
    ds_read_b64_tr_b16 v[56:57], v27 offset:18144
    ds_read_b64_tr_b16 v[58:59], v27 offset:19040
    v_mfma_f32_32x32x16_bf16 v[144:159], v[36:39], v[208:211], v[144:159]
    ds_read_b64_tr_b16 v[60:61], v27 offset:18176
    ds_read_b64_tr_b16 v[62:63], v27 offset:19072
    s_waitcnt lgkmcnt(8)
    v_mfma_f32_32x32x16_bf16 v[160:175], v[40:43], v[208:211], v[160:175]
    ds_read_b64_tr_b16 v[32:33], v27 offset:18208
    ds_read_b64_tr_b16 v[34:35], v27 offset:19104
    s_waitcnt vmcnt(2)
    s_barrier
    v_mfma_f32_32x32x16_bf16 v[64:79], v[44:47], v[212:215], v[64:79]
    ds_read_b64_tr_b16 v[36:37], v27 offset:18240
    ds_read_b64_tr_b16 v[38:39], v27 offset:19136
    s_waitcnt lgkmcnt(8)
    v_mfma_f32_32x32x16_bf16 v[80:95], v[48:51], v[212:215], v[80:95]
    ds_read_b64_tr_b16 v[40:41], v26 offset:0
    ds_read_b64_tr_b16 v[42:43], v26 offset:896
    v_mfma_f32_32x32x16_bf16 v[96:111], v[52:55], v[212:215], v[96:111]
    ds_read_b64_tr_b16 v[44:45], v26 offset:32
    ds_read_b64_tr_b16 v[46:47], v26 offset:928
    s_waitcnt lgkmcnt(8)
    v_mfma_f32_32x32x16_bf16 v[112:127], v[56:59], v[212:215], v[112:127]
    ds_read_b64_tr_b16 v[48:49], v26 offset:64
    ds_read_b64_tr_b16 v[50:51], v26 offset:960
    v_mfma_f32_32x32x16_bf16 v[128:143], v[60:63], v[212:215], v[128:143]
    ds_read_b64_tr_b16 v[52:53], v26 offset:96
    ds_read_b64_tr_b16 v[54:55], v26 offset:992
    s_waitcnt lgkmcnt(8)
    v_mfma_f32_32x32x16_bf16 v[144:159], v[32:35], v[212:215], v[144:159]
    ds_read_b64_tr_b16 v[56:57], v26 offset:128
    ds_read_b64_tr_b16 v[58:59], v26 offset:1024
    v_mfma_f32_32x32x16_bf16 v[160:175], v[36:39], v[212:215], v[160:175]
    ds_read_b64_tr_b16 v[60:61], v26 offset:160
    ds_read_b64_tr_b16 v[62:63], v26 offset:1056
    s_waitcnt lgkmcnt(8)
    v_mfma_f32_32x32x16_bf16 v[64:79], v[40:43], v[176:179], v[64:79]
    ds_read_b64_tr_b16 v[32:33], v26 offset:192
    ds_read_b64_tr_b16 v[34:35], v26 offset:1088
    v_mfma_f32_32x32x16_bf16 v[80:95], v[44:47], v[176:179], v[80:95]
    ds_read_b64_tr_b16 v[36:37], v26 offset:3584
    ds_read_b64_tr_b16 v[38:39], v26 offset:4480
    s_waitcnt lgkmcnt(8)
    v_mfma_f32_32x32x16_bf16 v[96:111], v[48:51], v[176:179], v[96:111]
    ds_read_b64_tr_b16 v[40:41], v26 offset:3616
    ds_read_b64_tr_b16 v[42:43], v26 offset:4512
    v_mfma_f32_32x32x16_bf16 v[112:127], v[52:55], v[176:179], v[112:127]
    ds_read_b64_tr_b16 v[44:45], v26 offset:3648
    ds_read_b64_tr_b16 v[46:47], v26 offset:4544
    s_waitcnt lgkmcnt(8)
    v_mfma_f32_32x32x16_bf16 v[128:143], v[56:59], v[176:179], v[128:143]
    ds_read_b64_tr_b16 v[48:49], v26 offset:3680
    ds_read_b64_tr_b16 v[50:51], v26 offset:4576
    v_mfma_f32_32x32x16_bf16 v[144:159], v[60:63], v[176:179], v[144:159]
    ds_read_b64_tr_b16 v[52:53], v26 offset:3712
    ds_read_b64_tr_b16 v[54:55], v26 offset:4608
    s_waitcnt lgkmcnt(8)
    v_mfma_f32_32x32x16_bf16 v[160:175], v[32:35], v[176:179], v[160:175]
    ds_read_b64_tr_b16 v[56:57], v26 offset:3744
    ds_read_b64_tr_b16 v[58:59], v26 offset:4640
    v_mfma_f32_32x32x16_bf16 v[64:79], v[36:39], v[180:183], v[64:79]
    ds_read_b64_tr_b16 v[60:61], v26 offset:3776
    ds_read_b64_tr_b16 v[62:63], v26 offset:4672
    s_waitcnt lgkmcnt(8)
    v_mfma_f32_32x32x16_bf16 v[80:95], v[40:43], v[180:183], v[80:95]
    v_mfma_f32_32x32x16_bf16 v[96:111], v[44:47], v[180:183], v[96:111]
    s_waitcnt lgkmcnt(4)
    v_mfma_f32_32x32x16_bf16 v[112:127], v[48:51], v[180:183], v[112:127]
    v_mfma_f32_32x32x16_bf16 v[128:143], v[52:55], v[180:183], v[128:143]
    s_waitcnt lgkmcnt(0)
    v_mfma_f32_32x32x16_bf16 v[144:159], v[56:59], v[180:183], v[144:159]
    v_mfma_f32_32x32x16_bf16 v[160:175], v[60:63], v[180:183], v[160:175]
    s_mul_i32 s44, s17, 7
    s_mul_i32 s45, s43, 57344
    s_add_u32 s45, s45, 0x800000
    v_bfe_u32 v20, v1, 4, 1
    v_mul_u32_u24 v20, 57344, v20
    v_lshrrev_b32 v21, 5, v1
    v_lshl_add_u32 v20, v21, 8, v20
    v_lshl_add_u32 v20, v3, 4, v20
    s_mov_b32 s48, 0xbfb8aa3b
    s_mov_b32 s49, 0xbfb8aa3b
    s_mov_b32 s50, 1.0
    s_mov_b32 s51, 1.0
    s_add_u32 s46, s44, 0
    s_lshr_b32 s47, s46, 1
    s_lshl_b32 s47, s47, 10
    s_and_b32 s46, s46, 1
    s_lshl_b32 s46, s46, 9
    s_add_u32 s46, s46, s47
    s_add_u32 s46, s46, s45
    v_cvt_pk_bf16_f32 v64, v64, v65
    v_cvt_pk_bf16_f32 v66, v66, v67
    v_cvt_pk_bf16_f32 v68, v68, v69
    v_cvt_pk_bf16_f32 v70, v70, v71
    v_and_b32 v65, 0xffff0000, v64
    v_lshlrev_b32 v64, 16, v64
    v_and_b32 v67, 0xffff0000, v66
    v_lshlrev_b32 v66, 16, v66
    v_and_b32 v69, 0xffff0000, v68
    v_lshlrev_b32 v68, 16, v68
    v_and_b32 v71, 0xffff0000, v70
    v_lshlrev_b32 v70, 16, v70
    v_pk_mul_f32 v[40:41], v[64:65], s[48:49]
    v_pk_mul_f32 v[42:43], v[66:67], s[48:49]
    v_pk_mul_f32 v[44:45], v[68:69], s[48:49]
    v_pk_mul_f32 v[46:47], v[70:71], s[48:49]
    v_exp_f32 v40, v40
    v_exp_f32 v41, v41
    v_exp_f32 v42, v42
    v_exp_f32 v43, v43
    v_exp_f32 v44, v44
    v_exp_f32 v45, v45
    v_exp_f32 v46, v46
    v_exp_f32 v47, v47
    v_cvt_pk_bf16_f32 v72, v72, v73
    v_cvt_pk_bf16_f32 v74, v74, v75
    v_cvt_pk_bf16_f32 v76, v76, v77
    v_cvt_pk_bf16_f32 v78, v78, v79
    v_pk_add_f32 v[40:41], v[40:41], s[50:51]
    v_pk_add_f32 v[42:43], v[42:43], s[50:51]
    v_pk_add_f32 v[44:45], v[44:45], s[50:51]
    v_pk_add_f32 v[46:47], v[46:47], s[50:51]
    v_rcp_f32 v40, v40
    v_rcp_f32 v41, v41
    v_rcp_f32 v42, v42
    v_rcp_f32 v43, v43
    v_rcp_f32 v44, v44
    v_rcp_f32 v45, v45
    v_rcp_f32 v46, v46
    v_rcp_f32 v47, v47
    v_and_b32 v73, 0xffff0000, v72
    v_lshlrev_b32 v72, 16, v72
    v_and_b32 v75, 0xffff0000, v74
    v_lshlrev_b32 v74, 16, v74
    v_and_b32 v77, 0xffff0000, v76
    v_lshlrev_b32 v76, 16, v76
    v_and_b32 v79, 0xffff0000, v78
    v_lshlrev_b32 v78, 16, v78
    v_pk_mul_f32 v[64:65], v[64:65], v[40:41]
    v_pk_mul_f32 v[66:67], v[66:67], v[42:43]
    v_pk_mul_f32 v[68:69], v[68:69], v[44:45]
    v_pk_mul_f32 v[70:71], v[70:71], v[46:47]
    v_cvt_pk_bf16_f32 v64, v64, v65
    v_cvt_pk_bf16_f32 v66, v66, v67
    v_cvt_pk_bf16_f32 v68, v68, v69
    v_cvt_pk_bf16_f32 v70, v70, v71
    v_and_b32 v65, 0xffff0000, v64
    v_lshlrev_b32 v64, 16, v64
    v_and_b32 v67, 0xffff0000, v66
    v_lshlrev_b32 v66, 16, v66
    v_and_b32 v69, 0xffff0000, v68
    v_lshlrev_b32 v68, 16, v68
    v_and_b32 v71, 0xffff0000, v70
    v_lshlrev_b32 v70, 16, v70
    v_pk_mul_f32 v[64:65], v[64:65], v[72:73]
    v_pk_mul_f32 v[66:67], v[66:67], v[74:75]
    v_pk_mul_f32 v[68:69], v[68:69], v[76:77]
    v_pk_mul_f32 v[70:71], v[70:71], v[78:79]
    v_cvt_pk_bf16_f32 v32, v64, v65
    v_cvt_pk_bf16_f32 v33, v66, v67
    v_cvt_pk_bf16_f32 v34, v68, v69
    v_cvt_pk_bf16_f32 v35, v70, v71
    buffer_store_dwordx4 v[32:35], v20, s[8:11], s46 offen
    s_add_u32 s46, s44, 1
    s_lshr_b32 s47, s46, 1
    s_lshl_b32 s47, s47, 10
    s_and_b32 s46, s46, 1
    s_lshl_b32 s46, s46, 9
    s_add_u32 s46, s46, s47
    s_add_u32 s46, s46, s45
    v_cvt_pk_bf16_f32 v80, v80, v81
    v_cvt_pk_bf16_f32 v82, v82, v83
    v_cvt_pk_bf16_f32 v84, v84, v85
    v_cvt_pk_bf16_f32 v86, v86, v87
    v_and_b32 v81, 0xffff0000, v80
    v_lshlrev_b32 v80, 16, v80
    v_and_b32 v83, 0xffff0000, v82
    v_lshlrev_b32 v82, 16, v82
    v_and_b32 v85, 0xffff0000, v84
    v_lshlrev_b32 v84, 16, v84
    v_and_b32 v87, 0xffff0000, v86
    v_lshlrev_b32 v86, 16, v86
    v_pk_mul_f32 v[40:41], v[80:81], s[48:49]
    v_pk_mul_f32 v[42:43], v[82:83], s[48:49]
    v_pk_mul_f32 v[44:45], v[84:85], s[48:49]
    v_pk_mul_f32 v[46:47], v[86:87], s[48:49]
    v_exp_f32 v40, v40
    v_exp_f32 v41, v41
    v_exp_f32 v42, v42
    v_exp_f32 v43, v43
    v_exp_f32 v44, v44
    v_exp_f32 v45, v45
    v_exp_f32 v46, v46
    v_exp_f32 v47, v47
    v_cvt_pk_bf16_f32 v88, v88, v89
    v_cvt_pk_bf16_f32 v90, v90, v91
    v_cvt_pk_bf16_f32 v92, v92, v93
    v_cvt_pk_bf16_f32 v94, v94, v95
    v_pk_add_f32 v[40:41], v[40:41], s[50:51]
    v_pk_add_f32 v[42:43], v[42:43], s[50:51]
    v_pk_add_f32 v[44:45], v[44:45], s[50:51]
    v_pk_add_f32 v[46:47], v[46:47], s[50:51]
    v_rcp_f32 v40, v40
    v_rcp_f32 v41, v41
    v_rcp_f32 v42, v42
    v_rcp_f32 v43, v43
    v_rcp_f32 v44, v44
    v_rcp_f32 v45, v45
    v_rcp_f32 v46, v46
    v_rcp_f32 v47, v47
    v_and_b32 v89, 0xffff0000, v88
    v_lshlrev_b32 v88, 16, v88
    v_and_b32 v91, 0xffff0000, v90
    v_lshlrev_b32 v90, 16, v90
    v_and_b32 v93, 0xffff0000, v92
    v_lshlrev_b32 v92, 16, v92
    v_and_b32 v95, 0xffff0000, v94
    v_lshlrev_b32 v94, 16, v94
    v_pk_mul_f32 v[80:81], v[80:81], v[40:41]
    v_pk_mul_f32 v[82:83], v[82:83], v[42:43]
    v_pk_mul_f32 v[84:85], v[84:85], v[44:45]
    v_pk_mul_f32 v[86:87], v[86:87], v[46:47]
    v_cvt_pk_bf16_f32 v80, v80, v81
    v_cvt_pk_bf16_f32 v82, v82, v83
    v_cvt_pk_bf16_f32 v84, v84, v85
    v_cvt_pk_bf16_f32 v86, v86, v87
    v_and_b32 v81, 0xffff0000, v80
    v_lshlrev_b32 v80, 16, v80
    v_and_b32 v83, 0xffff0000, v82
    v_lshlrev_b32 v82, 16, v82
    v_and_b32 v85, 0xffff0000, v84
    v_lshlrev_b32 v84, 16, v84
    v_and_b32 v87, 0xffff0000, v86
    v_lshlrev_b32 v86, 16, v86
    v_pk_mul_f32 v[80:81], v[80:81], v[88:89]
    v_pk_mul_f32 v[82:83], v[82:83], v[90:91]
    v_pk_mul_f32 v[84:85], v[84:85], v[92:93]
    v_pk_mul_f32 v[86:87], v[86:87], v[94:95]
    v_cvt_pk_bf16_f32 v36, v80, v81
    v_cvt_pk_bf16_f32 v37, v82, v83
    v_cvt_pk_bf16_f32 v38, v84, v85
    v_cvt_pk_bf16_f32 v39, v86, v87
    buffer_store_dwordx4 v[36:39], v20, s[8:11], s46 offen
    s_add_u32 s46, s44, 2
    s_lshr_b32 s47, s46, 1
    s_lshl_b32 s47, s47, 10
    s_and_b32 s46, s46, 1
    s_lshl_b32 s46, s46, 9
    s_add_u32 s46, s46, s47
    s_add_u32 s46, s46, s45
    v_cvt_pk_bf16_f32 v96, v96, v97
    v_cvt_pk_bf16_f32 v98, v98, v99
    v_cvt_pk_bf16_f32 v100, v100, v101
    v_cvt_pk_bf16_f32 v102, v102, v103
    v_and_b32 v97, 0xffff0000, v96
    v_lshlrev_b32 v96, 16, v96
    v_and_b32 v99, 0xffff0000, v98
    v_lshlrev_b32 v98, 16, v98
    v_and_b32 v101, 0xffff0000, v100
    v_lshlrev_b32 v100, 16, v100
    v_and_b32 v103, 0xffff0000, v102
    v_lshlrev_b32 v102, 16, v102
    v_pk_mul_f32 v[40:41], v[96:97], s[48:49]
    v_pk_mul_f32 v[42:43], v[98:99], s[48:49]
    v_pk_mul_f32 v[44:45], v[100:101], s[48:49]
    v_pk_mul_f32 v[46:47], v[102:103], s[48:49]
    v_exp_f32 v40, v40
    v_exp_f32 v41, v41
    v_exp_f32 v42, v42
    v_exp_f32 v43, v43
    v_exp_f32 v44, v44
    v_exp_f32 v45, v45
    v_exp_f32 v46, v46
    v_exp_f32 v47, v47
    v_cvt_pk_bf16_f32 v104, v104, v105
    v_cvt_pk_bf16_f32 v106, v106, v107
    v_cvt_pk_bf16_f32 v108, v108, v109
    v_cvt_pk_bf16_f32 v110, v110, v111
    v_pk_add_f32 v[40:41], v[40:41], s[50:51]
    v_pk_add_f32 v[42:43], v[42:43], s[50:51]
    v_pk_add_f32 v[44:45], v[44:45], s[50:51]
    v_pk_add_f32 v[46:47], v[46:47], s[50:51]
    v_rcp_f32 v40, v40
    v_rcp_f32 v41, v41
    v_rcp_f32 v42, v42
    v_rcp_f32 v43, v43
    v_rcp_f32 v44, v44
    v_rcp_f32 v45, v45
    v_rcp_f32 v46, v46
    v_rcp_f32 v47, v47
    v_and_b32 v105, 0xffff0000, v104
    v_lshlrev_b32 v104, 16, v104
    v_and_b32 v107, 0xffff0000, v106
    v_lshlrev_b32 v106, 16, v106
    v_and_b32 v109, 0xffff0000, v108
    v_lshlrev_b32 v108, 16, v108
    v_and_b32 v111, 0xffff0000, v110
    v_lshlrev_b32 v110, 16, v110
    v_pk_mul_f32 v[96:97], v[96:97], v[40:41]
    v_pk_mul_f32 v[98:99], v[98:99], v[42:43]
    v_pk_mul_f32 v[100:101], v[100:101], v[44:45]
    v_pk_mul_f32 v[102:103], v[102:103], v[46:47]
    v_cvt_pk_bf16_f32 v96, v96, v97
    v_cvt_pk_bf16_f32 v98, v98, v99
    v_cvt_pk_bf16_f32 v100, v100, v101
    v_cvt_pk_bf16_f32 v102, v102, v103
    v_and_b32 v97, 0xffff0000, v96
    v_lshlrev_b32 v96, 16, v96
    v_and_b32 v99, 0xffff0000, v98
    v_lshlrev_b32 v98, 16, v98
    v_and_b32 v101, 0xffff0000, v100
    v_lshlrev_b32 v100, 16, v100
    v_and_b32 v103, 0xffff0000, v102
    v_lshlrev_b32 v102, 16, v102
    v_pk_mul_f32 v[96:97], v[96:97], v[104:105]
    v_pk_mul_f32 v[98:99], v[98:99], v[106:107]
    v_pk_mul_f32 v[100:101], v[100:101], v[108:109]
    v_pk_mul_f32 v[102:103], v[102:103], v[110:111]
    v_cvt_pk_bf16_f32 v32, v96, v97
    v_cvt_pk_bf16_f32 v33, v98, v99
    v_cvt_pk_bf16_f32 v34, v100, v101
    v_cvt_pk_bf16_f32 v35, v102, v103
    buffer_store_dwordx4 v[32:35], v20, s[8:11], s46 offen
    s_add_u32 s46, s44, 3
    s_lshr_b32 s47, s46, 1
    s_lshl_b32 s47, s47, 10
    s_and_b32 s46, s46, 1
    s_lshl_b32 s46, s46, 9
    s_add_u32 s46, s46, s47
    s_add_u32 s46, s46, s45
    v_cvt_pk_bf16_f32 v112, v112, v113
    v_cvt_pk_bf16_f32 v114, v114, v115
    v_cvt_pk_bf16_f32 v116, v116, v117
    v_cvt_pk_bf16_f32 v118, v118, v119
    v_and_b32 v113, 0xffff0000, v112
    v_lshlrev_b32 v112, 16, v112
    v_and_b32 v115, 0xffff0000, v114
    v_lshlrev_b32 v114, 16, v114
    v_and_b32 v117, 0xffff0000, v116
    v_lshlrev_b32 v116, 16, v116
    v_and_b32 v119, 0xffff0000, v118
    v_lshlrev_b32 v118, 16, v118
    v_pk_mul_f32 v[40:41], v[112:113], s[48:49]
    v_pk_mul_f32 v[42:43], v[114:115], s[48:49]
    v_pk_mul_f32 v[44:45], v[116:117], s[48:49]
    v_pk_mul_f32 v[46:47], v[118:119], s[48:49]
    v_exp_f32 v40, v40
    v_exp_f32 v41, v41
    v_exp_f32 v42, v42
    v_exp_f32 v43, v43
    v_exp_f32 v44, v44
    v_exp_f32 v45, v45
    v_exp_f32 v46, v46
    v_exp_f32 v47, v47
    v_cvt_pk_bf16_f32 v120, v120, v121
    v_cvt_pk_bf16_f32 v122, v122, v123
    v_cvt_pk_bf16_f32 v124, v124, v125
    v_cvt_pk_bf16_f32 v126, v126, v127
    v_pk_add_f32 v[40:41], v[40:41], s[50:51]
    v_pk_add_f32 v[42:43], v[42:43], s[50:51]
    v_pk_add_f32 v[44:45], v[44:45], s[50:51]
    v_pk_add_f32 v[46:47], v[46:47], s[50:51]
    v_rcp_f32 v40, v40
    v_rcp_f32 v41, v41
    v_rcp_f32 v42, v42
    v_rcp_f32 v43, v43
    v_rcp_f32 v44, v44
    v_rcp_f32 v45, v45
    v_rcp_f32 v46, v46
    v_rcp_f32 v47, v47
    v_and_b32 v121, 0xffff0000, v120
    v_lshlrev_b32 v120, 16, v120
    v_and_b32 v123, 0xffff0000, v122
    v_lshlrev_b32 v122, 16, v122
    v_and_b32 v125, 0xffff0000, v124
    v_lshlrev_b32 v124, 16, v124
    v_and_b32 v127, 0xffff0000, v126
    v_lshlrev_b32 v126, 16, v126
    v_pk_mul_f32 v[112:113], v[112:113], v[40:41]
    v_pk_mul_f32 v[114:115], v[114:115], v[42:43]
    v_pk_mul_f32 v[116:117], v[116:117], v[44:45]
    v_pk_mul_f32 v[118:119], v[118:119], v[46:47]
    v_cvt_pk_bf16_f32 v112, v112, v113
    v_cvt_pk_bf16_f32 v114, v114, v115
    v_cvt_pk_bf16_f32 v116, v116, v117
    v_cvt_pk_bf16_f32 v118, v118, v119
    v_and_b32 v113, 0xffff0000, v112
    v_lshlrev_b32 v112, 16, v112
    v_and_b32 v115, 0xffff0000, v114
    v_lshlrev_b32 v114, 16, v114
    v_and_b32 v117, 0xffff0000, v116
    v_lshlrev_b32 v116, 16, v116
    v_and_b32 v119, 0xffff0000, v118
    v_lshlrev_b32 v118, 16, v118
    v_pk_mul_f32 v[112:113], v[112:113], v[120:121]
    v_pk_mul_f32 v[114:115], v[114:115], v[122:123]
    v_pk_mul_f32 v[116:117], v[116:117], v[124:125]
    v_pk_mul_f32 v[118:119], v[118:119], v[126:127]
    v_cvt_pk_bf16_f32 v36, v112, v113
    v_cvt_pk_bf16_f32 v37, v114, v115
    v_cvt_pk_bf16_f32 v38, v116, v117
    v_cvt_pk_bf16_f32 v39, v118, v119
    buffer_store_dwordx4 v[36:39], v20, s[8:11], s46 offen
    s_add_u32 s46, s44, 4
    s_lshr_b32 s47, s46, 1
    s_lshl_b32 s47, s47, 10
    s_and_b32 s46, s46, 1
    s_lshl_b32 s46, s46, 9
    s_add_u32 s46, s46, s47
    s_add_u32 s46, s46, s45
    v_cvt_pk_bf16_f32 v128, v128, v129
    v_cvt_pk_bf16_f32 v130, v130, v131
    v_cvt_pk_bf16_f32 v132, v132, v133
    v_cvt_pk_bf16_f32 v134, v134, v135
    v_and_b32 v129, 0xffff0000, v128
    v_lshlrev_b32 v128, 16, v128
    v_and_b32 v131, 0xffff0000, v130
    v_lshlrev_b32 v130, 16, v130
    v_and_b32 v133, 0xffff0000, v132
    v_lshlrev_b32 v132, 16, v132
    v_and_b32 v135, 0xffff0000, v134
    v_lshlrev_b32 v134, 16, v134
    v_pk_mul_f32 v[40:41], v[128:129], s[48:49]
    v_pk_mul_f32 v[42:43], v[130:131], s[48:49]
    v_pk_mul_f32 v[44:45], v[132:133], s[48:49]
    v_pk_mul_f32 v[46:47], v[134:135], s[48:49]
    v_exp_f32 v40, v40
    v_exp_f32 v41, v41
    v_exp_f32 v42, v42
    v_exp_f32 v43, v43
    v_exp_f32 v44, v44
    v_exp_f32 v45, v45
    v_exp_f32 v46, v46
    v_exp_f32 v47, v47
    v_cvt_pk_bf16_f32 v136, v136, v137
    v_cvt_pk_bf16_f32 v138, v138, v139
    v_cvt_pk_bf16_f32 v140, v140, v141
    v_cvt_pk_bf16_f32 v142, v142, v143
    v_pk_add_f32 v[40:41], v[40:41], s[50:51]
    v_pk_add_f32 v[42:43], v[42:43], s[50:51]
    v_pk_add_f32 v[44:45], v[44:45], s[50:51]
    v_pk_add_f32 v[46:47], v[46:47], s[50:51]
    v_rcp_f32 v40, v40
    v_rcp_f32 v41, v41
    v_rcp_f32 v42, v42
    v_rcp_f32 v43, v43
    v_rcp_f32 v44, v44
    v_rcp_f32 v45, v45
    v_rcp_f32 v46, v46
    v_rcp_f32 v47, v47
    v_and_b32 v137, 0xffff0000, v136
    v_lshlrev_b32 v136, 16, v136
    v_and_b32 v139, 0xffff0000, v138
    v_lshlrev_b32 v138, 16, v138
    v_and_b32 v141, 0xffff0000, v140
    v_lshlrev_b32 v140, 16, v140
    v_and_b32 v143, 0xffff0000, v142
    v_lshlrev_b32 v142, 16, v142
    v_pk_mul_f32 v[128:129], v[128:129], v[40:41]
    v_pk_mul_f32 v[130:131], v[130:131], v[42:43]
    v_pk_mul_f32 v[132:133], v[132:133], v[44:45]
    v_pk_mul_f32 v[134:135], v[134:135], v[46:47]
    v_cvt_pk_bf16_f32 v128, v128, v129
    v_cvt_pk_bf16_f32 v130, v130, v131
    v_cvt_pk_bf16_f32 v132, v132, v133
    v_cvt_pk_bf16_f32 v134, v134, v135
    v_and_b32 v129, 0xffff0000, v128
    v_lshlrev_b32 v128, 16, v128
    v_and_b32 v131, 0xffff0000, v130
    v_lshlrev_b32 v130, 16, v130
    v_and_b32 v133, 0xffff0000, v132
    v_lshlrev_b32 v132, 16, v132
    v_and_b32 v135, 0xffff0000, v134
    v_lshlrev_b32 v134, 16, v134
    v_pk_mul_f32 v[128:129], v[128:129], v[136:137]
    v_pk_mul_f32 v[130:131], v[130:131], v[138:139]
    v_pk_mul_f32 v[132:133], v[132:133], v[140:141]
    v_pk_mul_f32 v[134:135], v[134:135], v[142:143]
    v_cvt_pk_bf16_f32 v32, v128, v129
    v_cvt_pk_bf16_f32 v33, v130, v131
    v_cvt_pk_bf16_f32 v34, v132, v133
    v_cvt_pk_bf16_f32 v35, v134, v135
    buffer_store_dwordx4 v[32:35], v20, s[8:11], s46 offen
    s_add_u32 s46, s44, 5
    s_lshr_b32 s47, s46, 1
    s_lshl_b32 s47, s47, 10
    s_and_b32 s46, s46, 1
    s_lshl_b32 s46, s46, 9
    s_add_u32 s46, s46, s47
    s_add_u32 s46, s46, s45
    v_cvt_pk_bf16_f32 v144, v144, v145
    v_cvt_pk_bf16_f32 v146, v146, v147
    v_cvt_pk_bf16_f32 v148, v148, v149
    v_cvt_pk_bf16_f32 v150, v150, v151
    v_and_b32 v145, 0xffff0000, v144
    v_lshlrev_b32 v144, 16, v144
    v_and_b32 v147, 0xffff0000, v146
    v_lshlrev_b32 v146, 16, v146
    v_and_b32 v149, 0xffff0000, v148
    v_lshlrev_b32 v148, 16, v148
    v_and_b32 v151, 0xffff0000, v150
    v_lshlrev_b32 v150, 16, v150
    v_pk_mul_f32 v[40:41], v[144:145], s[48:49]
    v_pk_mul_f32 v[42:43], v[146:147], s[48:49]
    v_pk_mul_f32 v[44:45], v[148:149], s[48:49]
    v_pk_mul_f32 v[46:47], v[150:151], s[48:49]
    v_exp_f32 v40, v40
    v_exp_f32 v41, v41
    v_exp_f32 v42, v42
    v_exp_f32 v43, v43
    v_exp_f32 v44, v44
    v_exp_f32 v45, v45
    v_exp_f32 v46, v46
    v_exp_f32 v47, v47
    v_cvt_pk_bf16_f32 v152, v152, v153
    v_cvt_pk_bf16_f32 v154, v154, v155
    v_cvt_pk_bf16_f32 v156, v156, v157
    v_cvt_pk_bf16_f32 v158, v158, v159
    v_pk_add_f32 v[40:41], v[40:41], s[50:51]
    v_pk_add_f32 v[42:43], v[42:43], s[50:51]
    v_pk_add_f32 v[44:45], v[44:45], s[50:51]
    v_pk_add_f32 v[46:47], v[46:47], s[50:51]
    v_rcp_f32 v40, v40
    v_rcp_f32 v41, v41
    v_rcp_f32 v42, v42
    v_rcp_f32 v43, v43
    v_rcp_f32 v44, v44
    v_rcp_f32 v45, v45
    v_rcp_f32 v46, v46
    v_rcp_f32 v47, v47
    v_and_b32 v153, 0xffff0000, v152
    v_lshlrev_b32 v152, 16, v152
    v_and_b32 v155, 0xffff0000, v154
    v_lshlrev_b32 v154, 16, v154
    v_and_b32 v157, 0xffff0000, v156
    v_lshlrev_b32 v156, 16, v156
    v_and_b32 v159, 0xffff0000, v158
    v_lshlrev_b32 v158, 16, v158
    v_pk_mul_f32 v[144:145], v[144:145], v[40:41]
    v_pk_mul_f32 v[146:147], v[146:147], v[42:43]
    v_pk_mul_f32 v[148:149], v[148:149], v[44:45]
    v_pk_mul_f32 v[150:151], v[150:151], v[46:47]
    v_cvt_pk_bf16_f32 v144, v144, v145
    v_cvt_pk_bf16_f32 v146, v146, v147
    v_cvt_pk_bf16_f32 v148, v148, v149
    v_cvt_pk_bf16_f32 v150, v150, v151
    v_and_b32 v145, 0xffff0000, v144
    v_lshlrev_b32 v144, 16, v144
    v_and_b32 v147, 0xffff0000, v146
    v_lshlrev_b32 v146, 16, v146
    v_and_b32 v149, 0xffff0000, v148
    v_lshlrev_b32 v148, 16, v148
    v_and_b32 v151, 0xffff0000, v150
    v_lshlrev_b32 v150, 16, v150
    v_pk_mul_f32 v[144:145], v[144:145], v[152:153]
    v_pk_mul_f32 v[146:147], v[146:147], v[154:155]
    v_pk_mul_f32 v[148:149], v[148:149], v[156:157]
    v_pk_mul_f32 v[150:151], v[150:151], v[158:159]
    v_cvt_pk_bf16_f32 v36, v144, v145
    v_cvt_pk_bf16_f32 v37, v146, v147
    v_cvt_pk_bf16_f32 v38, v148, v149
    v_cvt_pk_bf16_f32 v39, v150, v151
    buffer_store_dwordx4 v[36:39], v20, s[8:11], s46 offen
    s_add_u32 s46, s44, 6
    s_lshr_b32 s47, s46, 1
    s_lshl_b32 s47, s47, 10
    s_and_b32 s46, s46, 1
    s_lshl_b32 s46, s46, 9
    s_add_u32 s46, s46, s47
    s_add_u32 s46, s46, s45
    v_cvt_pk_bf16_f32 v160, v160, v161
    v_cvt_pk_bf16_f32 v162, v162, v163
    v_cvt_pk_bf16_f32 v164, v164, v165
    v_cvt_pk_bf16_f32 v166, v166, v167
    v_and_b32 v161, 0xffff0000, v160
    v_lshlrev_b32 v160, 16, v160
    v_and_b32 v163, 0xffff0000, v162
    v_lshlrev_b32 v162, 16, v162
    v_and_b32 v165, 0xffff0000, v164
    v_lshlrev_b32 v164, 16, v164
    v_and_b32 v167, 0xffff0000, v166
    v_lshlrev_b32 v166, 16, v166
    v_pk_mul_f32 v[40:41], v[160:161], s[48:49]
    v_pk_mul_f32 v[42:43], v[162:163], s[48:49]
    v_pk_mul_f32 v[44:45], v[164:165], s[48:49]
    v_pk_mul_f32 v[46:47], v[166:167], s[48:49]
    v_exp_f32 v40, v40
    v_exp_f32 v41, v41
    v_exp_f32 v42, v42
    v_exp_f32 v43, v43
    v_exp_f32 v44, v44
    v_exp_f32 v45, v45
    v_exp_f32 v46, v46
    v_exp_f32 v47, v47
    v_cvt_pk_bf16_f32 v168, v168, v169
    v_cvt_pk_bf16_f32 v170, v170, v171
    v_cvt_pk_bf16_f32 v172, v172, v173
    v_cvt_pk_bf16_f32 v174, v174, v175
    v_pk_add_f32 v[40:41], v[40:41], s[50:51]
    v_pk_add_f32 v[42:43], v[42:43], s[50:51]
    v_pk_add_f32 v[44:45], v[44:45], s[50:51]
    v_pk_add_f32 v[46:47], v[46:47], s[50:51]
    v_rcp_f32 v40, v40
    v_rcp_f32 v41, v41
    v_rcp_f32 v42, v42
    v_rcp_f32 v43, v43
    v_rcp_f32 v44, v44
    v_rcp_f32 v45, v45
    v_rcp_f32 v46, v46
    v_rcp_f32 v47, v47
    v_and_b32 v169, 0xffff0000, v168
    v_lshlrev_b32 v168, 16, v168
    v_and_b32 v171, 0xffff0000, v170
    v_lshlrev_b32 v170, 16, v170
    v_and_b32 v173, 0xffff0000, v172
    v_lshlrev_b32 v172, 16, v172
    v_and_b32 v175, 0xffff0000, v174
    v_lshlrev_b32 v174, 16, v174
    v_pk_mul_f32 v[160:161], v[160:161], v[40:41]
    v_pk_mul_f32 v[162:163], v[162:163], v[42:43]
    v_pk_mul_f32 v[164:165], v[164:165], v[44:45]
    v_pk_mul_f32 v[166:167], v[166:167], v[46:47]
    v_cvt_pk_bf16_f32 v160, v160, v161
    v_cvt_pk_bf16_f32 v162, v162, v163
    v_cvt_pk_bf16_f32 v164, v164, v165
    v_cvt_pk_bf16_f32 v166, v166, v167
    v_and_b32 v161, 0xffff0000, v160
    v_lshlrev_b32 v160, 16, v160
    v_and_b32 v163, 0xffff0000, v162
    v_lshlrev_b32 v162, 16, v162
    v_and_b32 v165, 0xffff0000, v164
    v_lshlrev_b32 v164, 16, v164
    v_and_b32 v167, 0xffff0000, v166
    v_lshlrev_b32 v166, 16, v166
    v_pk_mul_f32 v[160:161], v[160:161], v[168:169]
    v_pk_mul_f32 v[162:163], v[162:163], v[170:171]
    v_pk_mul_f32 v[164:165], v[164:165], v[172:173]
    v_pk_mul_f32 v[166:167], v[166:167], v[174:175]
    v_cvt_pk_bf16_f32 v32, v160, v161
    v_cvt_pk_bf16_f32 v33, v162, v163
    v_cvt_pk_bf16_f32 v34, v164, v165
    v_cvt_pk_bf16_f32 v35, v166, v167
    buffer_store_dwordx4 v[32:35], v20, s[8:11], s46 offen
    s_endpgm
K2_kgen:
    s_and_b32 s2, s2, 0xff
    s_load_dwordx4 s[52:55], s[0:1], 8
    s_load_dwordx4 s[56:59], s[0:1], 24
    s_load_dwordx4 s[60:63], s[0:1], 40
    s_and_b32 s19, s2, 7
    s_lshr_b32 s20, s2, 3
    s_lshl_b32 s51, s19, 6
    s_lshl_b32 s21, s20, 1
    s_add_u32 s51, s51, s21
    s_lshl_b32 s19, s51, 1
    s_and_b32 s31, s16, 1
    s_lshr_b32 s32, s16, 1
    s_add_u32 s33, s51, s32
    s_mul_i32 s34, s32, 14912
    s_add_u32 s34, s34, 4608
    s_lshl_b32 s35, s31, 7
    v_add_u32 v5, s35, v1
    v_sub_u32 v6, 0xff, v5
    v_lshlrev_b32 v6, 13, v6
    s_lshl_b32 s36, s33, 4
    s_add_u32 s36, s36, 0x200000
    s_lshl_b32 s37, s31, 11
    s_add_u32 s37, s37, s34
    v_lshlrev_b32 v8, 1, v1
    s_lshl_b32 s44, s33, 8
    s_add_u32 s44, s44, s35
    s_waitcnt lgkmcnt(0)
    s_load_dword s46, s[60:61], s19
    s_load_dword s30, s[62:63], s19
    s_mov_b32 s8, s4
    s_mov_b32 s9, s5
    s_mov_b32 s10, 0x1200000
    s_mov_b32 s11, 0x00020000
    s_mov_b32 s64, s52
    s_mov_b32 s65, s53
    s_mov_b32 s66, 0x20000
    s_mov_b32 s67, 0x00020000
    s_mov_b32 s68, s54
    s_mov_b32 s69, s55
    s_mov_b32 s70, 0x20000
    s_mov_b32 s71, 0x00020000
    s_mov_b32 s72, s56
    s_mov_b32 s73, s57
    s_mov_b32 s74, 0x20000
    s_mov_b32 s75, 0x00020000
    s_mov_b32 s76, s58
    s_mov_b32 s77, s59
    s_mov_b32 s78, 0x20000
    s_mov_b32 s79, 0x00020000
    buffer_load_ushort v12, v8, s[64:67], s44 offen
    buffer_load_ushort v13, v8, s[68:71], s44 offen
    buffer_load_ushort v14, v8, s[72:75], s44 offen
    buffer_load_ushort v15, v8, s[76:79], s44 offen
    v_lshrrev_b32 v24, 3, v3
    v_lshlrev_b32 v24, 7, v24
    v_and_b32 v28, 7, v3
    v_add_u32 v24, v24, v28
    v_lshrrev_b32 v25, 2, v3
    v_lshlrev_b32 v25, 7, v25
    v_and_b32 v28, 3, v3
    v_lshl_add_u32 v25, v28, 1, v25
    v_add_u32 v25, 0x100, v25
    v_and_b32 v28, 7, v3
    v_lshrrev_b32 v28, 1, v28
    v_lshlrev_b32 v28, 7, v28
    v_and_b32 v29, 1, v3
    v_lshl_add_u32 v28, v29, 2, v28
    v_add_u32 v28, 0x200, v28
    v_cmp_gt_u32 vcc, 8, v3
    s_nop 1
    v_cndmask_b32 v25, v28, v25, vcc
    v_lshlrev_b32 v26, 7, v3
    v_add_u32 v26, 0x400, v26
    v_lshlrev_b32 v27, 3, v3
    v_lshlrev_b32 v28, 2, v3
    ds_write_b32 v28, v24 offset:0
    ds_write_b32 v28, v25 offset:64
    ds_write_b32 v28, v26 offset:128
    s_lshl_b32 s21, s32, 2
    v_mov_b32 v31, s21
    v_mov_b32 v16, 0
    v_mov_b32 v17, 0
    v_mov_b32 v18, 0
    v_mov_b32 v19, 0
    ds_write_b32 v31, v16 offset:192
    v_cvt_f32_u32 v24, v24
    v_cvt_f32_u32 v25, v25
    v_cvt_f32_u32 v26, v26
    v_cvt_f32_u32 v27, v27
    s_waitcnt lgkmcnt(0)
    s_lshl_b32 s21, s32, 4
    s_lshr_b32 s46, s46, s21
    s_lshl_b32 s46, s46, 16
    s_lshr_b32 s48, s30, s21
    s_lshl_b32 s48, s48, 16
    v_mov_b32 v30, s46
    v_cvt_f64_f32 v[32:33], v30
    s_mov_b32 s22, 0x652b82fe
    s_mov_b32 s23, 0x3ff71547
    v_mul_f64 v[34:35], v[32:33], s[22:23]
    v_rndne_f64 v[34:35], v[34:35]
    s_mov_b32 s22, 0xfefa39ef
    s_mov_b32 s23, 0x3fe62e42
    v_fma_f64 v[36:37], -v[34:35], s[22:23], v[32:33]
    s_mov_b32 s22, 0x3b39803f
    s_mov_b32 s23, 0x3c7abc9e
    v_fma_f64 v[36:37], -v[34:35], s[22:23], v[36:37]
    v_mov_b32 v38, 0x13a86d09
    v_mov_b32 v39, 0x3de61246
    s_mov_b32 s22, 0xeff8d898
    s_mov_b32 s23, 0x3e21eed8
    v_fma_f64 v[38:39], v[38:39], v[36:37], s[22:23]
    s_mov_b32 s22, 0x67f544e4
    s_mov_b32 s23, 0x3e5ae645
    v_fma_f64 v[38:39], v[38:39], v[36:37], s[22:23]
    s_mov_b32 s22, 0xb7789f5c
    s_mov_b32 s23, 0x3e927e4f
    v_fma_f64 v[38:39], v[38:39], v[36:37], s[22:23]
    s_mov_b32 s22, 0xa556c734
    s_mov_b32 s23, 0x3ec71de3
    v_fma_f64 v[38:39], v[38:39], v[36:37], s[22:23]
    s_mov_b32 s22, 0x1a01a01a
    s_mov_b32 s23, 0x3efa01a0
    v_fma_f64 v[38:39], v[38:39], v[36:37], s[22:23]
    s_mov_b32 s22, 0x1a01a01a
    s_mov_b32 s23, 0x3f2a01a0
    v_fma_f64 v[38:39], v[38:39], v[36:37], s[22:23]
    s_mov_b32 s22, 0x16c16c17
    s_mov_b32 s23, 0x3f56c16c
    v_fma_f64 v[38:39], v[38:39], v[36:37], s[22:23]
    s_mov_b32 s22, 0x11111111
    s_mov_b32 s23, 0x3f811111
    v_fma_f64 v[38:39], v[38:39], v[36:37], s[22:23]
    s_mov_b32 s22, 0x55555555
    s_mov_b32 s23, 0x3fa55555
    v_fma_f64 v[38:39], v[38:39], v[36:37], s[22:23]
    s_mov_b32 s22, 0x55555555
    s_mov_b32 s23, 0x3fc55555
    v_fma_f64 v[38:39], v[38:39], v[36:37], s[22:23]
    s_mov_b32 s22, 0x0
    s_mov_b32 s23, 0x3fe00000
    v_fma_f64 v[38:39], v[38:39], v[36:37], s[22:23]
    s_mov_b32 s22, 0x0
    s_mov_b32 s23, 0x3ff00000
    v_fma_f64 v[38:39], v[38:39], v[36:37], s[22:23]
    s_mov_b32 s22, 0x0
    s_mov_b32 s23, 0x3ff00000
    v_fma_f64 v[38:39], v[38:39], v[36:37], s[22:23]
    v_cvt_i32_f64 v30, v[34:35]
    v_ldexp_f64 v[38:39], v[38:39], v30
    v_cvt_f32_f64 v30, v[38:39]
    v_cvt_pk_bf16_f32 v30, v30, v30
    v_lshlrev_b32 v30, 16, v30
    s_mov_b32 s50, 0x3fb8aa3b
    s_mul_i32 s47, s32, 12288
    s_add_u32 s47, s47, 50816
    v_and_b32 v40, 0x7f, v0
    v_lshlrev_b32 v40, 1, v40
    v_add_u32 v192, 0, v40
    v_add_u32 v193, 1, v40
    v_cvt_f32_u32 v192, v192
    v_cvt_f32_u32 v193, v193
    v_cvt_pk_bf16_f32 v192, v192, v193
    v_and_b32 v193, 0xffff0000, v192
    v_lshlrev_b32 v192, 16, v192
    v_cvt_u32_f32 v192, v192
    v_cvt_u32_f32 v193, v193
    v_lshl_add_u32 v192, v192, 2, s47
    v_lshl_add_u32 v193, v193, 2, s47
    v_add_u32 v194, 256, v40
    v_add_u32 v195, 257, v40
    v_cvt_f32_u32 v194, v194
    v_cvt_f32_u32 v195, v195
    v_cvt_pk_bf16_f32 v194, v194, v195
    v_and_b32 v195, 0xffff0000, v194
    v_lshlrev_b32 v194, 16, v194
    v_cvt_u32_f32 v194, v194
    v_cvt_u32_f32 v195, v195
    v_lshl_add_u32 v194, v194, 2, s47
    v_lshl_add_u32 v195, v195, 2, s47
    v_add_u32 v196, 512, v40
    v_add_u32 v197, 513, v40
    v_cvt_f32_u32 v196, v196
    v_cvt_f32_u32 v197, v197
    v_cvt_pk_bf16_f32 v196, v196, v197
    v_and_b32 v197, 0xffff0000, v196
    v_lshlrev_b32 v196, 16, v196
    v_cvt_u32_f32 v196, v196
    v_cvt_u32_f32 v197, v197
    v_lshl_add_u32 v196, v196, 2, s47
    v_lshl_add_u32 v197, v197, 2, s47
    v_add_u32 v198, 768, v40
    v_add_u32 v199, 769, v40
    v_cvt_f32_u32 v198, v198
    v_cvt_f32_u32 v199, v199
    v_cvt_pk_bf16_f32 v198, v198, v199
    v_and_b32 v199, 0xffff0000, v198
    v_lshlrev_b32 v198, 16, v198
    v_cvt_u32_f32 v198, v198
    v_cvt_u32_f32 v199, v199
    v_lshl_add_u32 v198, v198, 2, s47
    v_lshl_add_u32 v199, v199, 2, s47
    v_add_u32 v200, 1024, v40
    v_add_u32 v201, 1025, v40
    v_cvt_f32_u32 v200, v200
    v_cvt_f32_u32 v201, v201
    v_cvt_pk_bf16_f32 v200, v200, v201
    v_and_b32 v201, 0xffff0000, v200
    v_lshlrev_b32 v200, 16, v200
    v_cvt_u32_f32 v200, v200
    v_cvt_u32_f32 v201, v201
    v_lshl_add_u32 v200, v200, 2, s47
    v_lshl_add_u32 v201, v201, 2, s47
    v_add_u32 v202, 1280, v40
    v_add_u32 v203, 1281, v40
    v_cvt_f32_u32 v202, v202
    v_cvt_f32_u32 v203, v203
    v_cvt_pk_bf16_f32 v202, v202, v203
    v_and_b32 v203, 0xffff0000, v202
    v_lshlrev_b32 v202, 16, v202
    v_cvt_u32_f32 v202, v202
    v_cvt_u32_f32 v203, v203
    v_lshl_add_u32 v202, v202, 2, s47
    v_lshl_add_u32 v203, v203, 2, s47
    v_add_u32 v204, 1536, v40
    v_add_u32 v205, 1537, v40
    v_cvt_f32_u32 v204, v204
    v_cvt_f32_u32 v205, v205
    v_cvt_pk_bf16_f32 v204, v204, v205
    v_and_b32 v205, 0xffff0000, v204
    v_lshlrev_b32 v204, 16, v204
    v_cvt_u32_f32 v204, v204
    v_cvt_u32_f32 v205, v205
    v_lshl_add_u32 v204, v204, 2, s47
    v_lshl_add_u32 v205, v205, 2, s47
    v_add_u32 v206, 1792, v40
    v_add_u32 v207, 1793, v40
    v_cvt_f32_u32 v206, v206
    v_cvt_f32_u32 v207, v207
    v_cvt_pk_bf16_f32 v206, v206, v207
    v_and_b32 v207, 0xffff0000, v206
    v_lshlrev_b32 v206, 16, v206
    v_cvt_u32_f32 v206, v206
    v_cvt_u32_f32 v207, v207
    v_lshl_add_u32 v206, v206, 2, s47
    v_lshl_add_u32 v207, v207, 2, s47
    s_waitcnt vmcnt(0)
    v_lshlrev_b32 v12, 16, v12
    v_lshlrev_b32 v13, 16, v13
    v_lshlrev_b32 v14, 16, v14
    v_lshlrev_b32 v15, 16, v15
    v_mul_f32 v56, 0x3fb8aa3b, v12
    v_fma_f32 v57, v12, s50, -v56
    v_fmac_f32 v57, 0x32a57060, v12
    v_exp_f32 v56, v56
    v_mul_f32 v57, 0x3f317218, v57
    v_mul_f32 v13, v13, v30
    v_fma_f32 v56, v56, v57, v56
    v_mul_f32 v14, v14, v30
    v_mul_f32 v15, v15, v30
    v_cvt_pk_bf16_f32 v56, v56, v56
    v_mul_f32 v13, 0.15915494, v13
    v_lshlrev_b32 v56, 16, v56
    v_add_f32 v14, v14, v14
    v_add_f32 v15, v15, v15
    v_mul_f32 v56, v56, v30
    v_mul_f32 v12, 0xbfb8aa3b, v56
    s_lshl_b32 s21, s16, 10
    s_add_u32 s21, s21, 512
    v_add_u32 v9, s21, v7
    ds_write_b128 v9, v[12:15]
    v_lshl_add_u32 v9, v4, 8, s21
    s_waitcnt lgkmcnt(0)
    ds_read_b128 v[128:131], v9 offset:0
    ds_read_b128 v[132:135], v9 offset:16
    ds_read_b128 v[136:139], v9 offset:32
    ds_read_b128 v[140:143], v9 offset:48
    ds_read_b128 v[144:147], v9 offset:64
    ds_read_b128 v[148:151], v9 offset:80
    ds_read_b128 v[152:155], v9 offset:96
    ds_read_b128 v[156:159], v9 offset:112
    ds_read_b128 v[160:163], v9 offset:128
    ds_read_b128 v[164:167], v9 offset:144
    ds_read_b128 v[168:171], v9 offset:160
    ds_read_b128 v[172:175], v9 offset:176
    ds_read_b128 v[176:179], v9 offset:192
    ds_read_b128 v[180:183], v9 offset:208
    ds_read_b128 v[184:187], v9 offset:224
    ds_read_b128 v[188:191], v9 offset:240
    s_waitcnt lgkmcnt(12)
    v_mul_f32 v32, v128, v27
    v_mul_f32 v33, v129, v27
    v_mul_f32 v35, v128, v24
    v_mul_f32 v36, v129, v24
    v_mul_f32 v38, v128, v25
    v_mul_f32 v39, v129, v25
    v_mul_f32 v41, v128, v26
    v_mul_f32 v42, v129, v26
    v_exp_f32 v32, v32
    v_fract_f32 v33, v33
    v_exp_f32 v35, v35
    v_fract_f32 v36, v36
    v_exp_f32 v38, v38
    v_fract_f32 v39, v39
    v_exp_f32 v41, v41
    v_fract_f32 v42, v42
    v_sin_f32 v34, v33
    v_cos_f32 v33, v33
    v_sin_f32 v37, v36
    v_cos_f32 v36, v36
    v_sin_f32 v40, v39
    v_cos_f32 v39, v39
    v_sin_f32 v43, v42
    v_cos_f32 v42, v42
    v_mul_f32 v33, v32, v33
    v_mul_f32 v34, v32, v34
    v_mul_f32 v36, v35, v36
    v_mul_f32 v37, v35, v37
    v_mul_f32 v39, v38, v39
    v_mul_f32 v40, v38, v40
    v_mul_f32 v42, v41, v42
    v_mul_f32 v43, v41, v43
    v_mul_f32 v44, v131, v34
    v_mul_f32 v45, v131, v33
    v_fma_f32 v44, v130, v33, -v44
    v_fma_f32 v45, -v130, v34, -v45
    v_cvt_pk_bf16_f32 v52, v44, v45
    v_cvt_pk_bf16_f32 v96, v36, v37
    v_cvt_pk_bf16_f32 v104, v39, v40
    v_cvt_pk_bf16_f32 v112, v42, v43
    v_lshlrev_b32 v46, 16, v52
    v_and_b32 v47, 0xffff0000, v52
    v_sub_f32 v44, v44, v46
    v_sub_f32 v45, v45, v47
    v_cvt_pk_bf16_f32 v56, v44, v45
    v_lshlrev_b32 v48, 16, v96
    v_and_b32 v49, 0xffff0000, v96
    v_sub_f32 v36, v36, v48
    v_sub_f32 v37, v37, v49
    v_cvt_pk_bf16_f32 v100, v36, v37
    v_lshlrev_b32 v46, 16, v104
    v_and_b32 v47, 0xffff0000, v104
    v_sub_f32 v39, v39, v46
    v_sub_f32 v40, v40, v47
    v_cvt_pk_bf16_f32 v108, v39, v40
    v_lshlrev_b32 v48, 16, v112
    v_and_b32 v49, 0xffff0000, v112
    v_sub_f32 v42, v42, v48
    v_sub_f32 v43, v43, v49
    v_cvt_pk_bf16_f32 v116, v42, v43
    v_mul_f32 v32, v132, v27
    v_mul_f32 v33, v133, v27
    v_mul_f32 v35, v132, v24
    v_mul_f32 v36, v133, v24
    v_mul_f32 v38, v132, v25
    v_mul_f32 v39, v133, v25
    v_mul_f32 v41, v132, v26
    v_mul_f32 v42, v133, v26
    v_exp_f32 v32, v32
    v_fract_f32 v33, v33
    v_exp_f32 v35, v35
    v_fract_f32 v36, v36
    v_exp_f32 v38, v38
    v_fract_f32 v39, v39
    v_exp_f32 v41, v41
    v_fract_f32 v42, v42
    v_sin_f32 v34, v33
    v_cos_f32 v33, v33
    v_sin_f32 v37, v36
    v_cos_f32 v36, v36
    v_sin_f32 v40, v39
    v_cos_f32 v39, v39
    v_sin_f32 v43, v42
    v_cos_f32 v42, v42
    v_mul_f32 v33, v32, v33
    v_mul_f32 v34, v32, v34
    v_mul_f32 v36, v35, v36
    v_mul_f32 v37, v35, v37
    v_mul_f32 v39, v38, v39
    v_mul_f32 v40, v38, v40
    v_mul_f32 v42, v41, v42
    v_mul_f32 v43, v41, v43
    v_mul_f32 v44, v135, v34
    v_mul_f32 v45, v135, v33
    v_fma_f32 v44, v134, v33, -v44
    v_fma_f32 v45, -v134, v34, -v45
    v_cvt_pk_bf16_f32 v53, v44, v45
    v_cvt_pk_bf16_f32 v97, v36, v37
    v_cvt_pk_bf16_f32 v105, v39, v40
    v_cvt_pk_bf16_f32 v113, v42, v43
    v_lshlrev_b32 v46, 16, v53
    v_and_b32 v47, 0xffff0000, v53
    v_sub_f32 v44, v44, v46
    v_sub_f32 v45, v45, v47
    v_cvt_pk_bf16_f32 v57, v44, v45
    v_lshlrev_b32 v48, 16, v97
    v_and_b32 v49, 0xffff0000, v97
    v_sub_f32 v36, v36, v48
    v_sub_f32 v37, v37, v49
    v_cvt_pk_bf16_f32 v101, v36, v37
    v_lshlrev_b32 v46, 16, v105
    v_and_b32 v47, 0xffff0000, v105
    v_sub_f32 v39, v39, v46
    v_sub_f32 v40, v40, v47
    v_cvt_pk_bf16_f32 v109, v39, v40
    v_lshlrev_b32 v48, 16, v113
    v_and_b32 v49, 0xffff0000, v113
    v_sub_f32 v42, v42, v48
    v_sub_f32 v43, v43, v49
    v_cvt_pk_bf16_f32 v117, v42, v43
    v_mul_f32 v32, v136, v27
    v_mul_f32 v33, v137, v27
    v_mul_f32 v35, v136, v24
    v_mul_f32 v36, v137, v24
    v_mul_f32 v38, v136, v25
    v_mul_f32 v39, v137, v25
    v_mul_f32 v41, v136, v26
    v_mul_f32 v42, v137, v26
    v_exp_f32 v32, v32
    v_fract_f32 v33, v33
    v_exp_f32 v35, v35
    v_fract_f32 v36, v36
    v_exp_f32 v38, v38
    v_fract_f32 v39, v39
    v_exp_f32 v41, v41
    v_fract_f32 v42, v42
    v_sin_f32 v34, v33
    v_cos_f32 v33, v33
    v_sin_f32 v37, v36
    v_cos_f32 v36, v36
    v_sin_f32 v40, v39
    v_cos_f32 v39, v39
    v_sin_f32 v43, v42
    v_cos_f32 v42, v42
    v_mul_f32 v33, v32, v33
    v_mul_f32 v34, v32, v34
    v_mul_f32 v36, v35, v36
    v_mul_f32 v37, v35, v37
    v_mul_f32 v39, v38, v39
    v_mul_f32 v40, v38, v40
    v_mul_f32 v42, v41, v42
    v_mul_f32 v43, v41, v43
    v_mul_f32 v44, v139, v34
    v_mul_f32 v45, v139, v33
    v_fma_f32 v44, v138, v33, -v44
    v_fma_f32 v45, -v138, v34, -v45
    v_cvt_pk_bf16_f32 v54, v44, v45
    v_cvt_pk_bf16_f32 v98, v36, v37
    v_cvt_pk_bf16_f32 v106, v39, v40
    v_cvt_pk_bf16_f32 v114, v42, v43
    v_lshlrev_b32 v46, 16, v54
    v_and_b32 v47, 0xffff0000, v54
    v_sub_f32 v44, v44, v46
    v_sub_f32 v45, v45, v47
    v_cvt_pk_bf16_f32 v58, v44, v45
    v_lshlrev_b32 v48, 16, v98
    v_and_b32 v49, 0xffff0000, v98
    v_sub_f32 v36, v36, v48
    v_sub_f32 v37, v37, v49
    v_cvt_pk_bf16_f32 v102, v36, v37
    v_lshlrev_b32 v46, 16, v106
    v_and_b32 v47, 0xffff0000, v106
    v_sub_f32 v39, v39, v46
    v_sub_f32 v40, v40, v47
    v_cvt_pk_bf16_f32 v110, v39, v40
    v_lshlrev_b32 v48, 16, v114
    v_and_b32 v49, 0xffff0000, v114
    v_sub_f32 v42, v42, v48
    v_sub_f32 v43, v43, v49
    v_cvt_pk_bf16_f32 v118, v42, v43
    s_waitcnt lgkmcnt(8)
    v_mul_f32 v32, v140, v27
    v_mul_f32 v33, v141, v27
    v_mul_f32 v35, v140, v24
    v_mul_f32 v36, v141, v24
    v_mul_f32 v38, v140, v25
    v_mul_f32 v39, v141, v25
    v_mul_f32 v41, v140, v26
    v_mul_f32 v42, v141, v26
    v_exp_f32 v32, v32
    v_fract_f32 v33, v33
    v_exp_f32 v35, v35
    v_fract_f32 v36, v36
    v_exp_f32 v38, v38
    v_fract_f32 v39, v39
    v_exp_f32 v41, v41
    v_fract_f32 v42, v42
    v_sin_f32 v34, v33
    v_cos_f32 v33, v33
    v_sin_f32 v37, v36
    v_cos_f32 v36, v36
    v_sin_f32 v40, v39
    v_cos_f32 v39, v39
    v_sin_f32 v43, v42
    v_cos_f32 v42, v42
    v_mul_f32 v33, v32, v33
    v_mul_f32 v34, v32, v34
    v_mul_f32 v36, v35, v36
    v_mul_f32 v37, v35, v37
    v_mul_f32 v39, v38, v39
    v_mul_f32 v40, v38, v40
    v_mul_f32 v42, v41, v42
    v_mul_f32 v43, v41, v43
    v_mul_f32 v44, v143, v34
    v_mul_f32 v45, v143, v33
    v_fma_f32 v44, v142, v33, -v44
    v_fma_f32 v45, -v142, v34, -v45
    v_cvt_pk_bf16_f32 v55, v44, v45
    v_cvt_pk_bf16_f32 v99, v36, v37
    v_cvt_pk_bf16_f32 v107, v39, v40
    v_cvt_pk_bf16_f32 v115, v42, v43
    v_lshlrev_b32 v46, 16, v55
    v_and_b32 v47, 0xffff0000, v55
    v_sub_f32 v44, v44, v46
    v_sub_f32 v45, v45, v47
    v_cvt_pk_bf16_f32 v59, v44, v45
    v_lshlrev_b32 v48, 16, v99
    v_and_b32 v49, 0xffff0000, v99
    v_sub_f32 v36, v36, v48
    v_sub_f32 v37, v37, v49
    v_cvt_pk_bf16_f32 v103, v36, v37
    v_lshlrev_b32 v46, 16, v107
    v_and_b32 v47, 0xffff0000, v107
    v_sub_f32 v39, v39, v46
    v_sub_f32 v40, v40, v47
    v_cvt_pk_bf16_f32 v111, v39, v40
    v_lshlrev_b32 v48, 16, v115
    v_and_b32 v49, 0xffff0000, v115
    v_sub_f32 v42, v42, v48
    v_sub_f32 v43, v43, v49
    v_cvt_pk_bf16_f32 v119, v42, v43
    v_mfma_f32_16x16x32_bf16 v[64:67], v[100:103], v[52:55], 0
    v_mfma_f32_16x16x32_bf16 v[64:67], v[96:99], v[56:59], v[64:67]
    v_mfma_f32_16x16x32_bf16 v[64:67], v[96:99], v[52:55], v[64:67]
    v_mfma_f32_16x16x32_bf16 v[68:71], v[108:111], v[52:55], 0
    v_mfma_f32_16x16x32_bf16 v[68:71], v[104:107], v[56:59], v[68:71]
    v_mfma_f32_16x16x32_bf16 v[68:71], v[104:107], v[52:55], v[68:71]
    v_mfma_f32_16x16x32_bf16 v[72:75], v[116:119], v[52:55], 0
    v_mfma_f32_16x16x32_bf16 v[72:75], v[112:115], v[56:59], v[72:75]
    v_mfma_f32_16x16x32_bf16 v[72:75], v[112:115], v[52:55], v[72:75]
    v_mul_f32 v32, v144, v27
    v_mul_f32 v33, v145, v27
    v_mul_f32 v35, v144, v24
    v_mul_f32 v36, v145, v24
    v_mul_f32 v38, v144, v25
    v_mul_f32 v39, v145, v25
    v_mul_f32 v41, v144, v26
    v_mul_f32 v42, v145, v26
    v_exp_f32 v32, v32
    v_fract_f32 v33, v33
    v_exp_f32 v35, v35
    v_fract_f32 v36, v36
    v_exp_f32 v38, v38
    v_fract_f32 v39, v39
    v_exp_f32 v41, v41
    v_fract_f32 v42, v42
    v_sin_f32 v34, v33
    v_cos_f32 v33, v33
    v_sin_f32 v37, v36
    v_cos_f32 v36, v36
    v_sin_f32 v40, v39
    v_cos_f32 v39, v39
    v_sin_f32 v43, v42
    v_cos_f32 v42, v42
    v_mul_f32 v33, v32, v33
    v_mul_f32 v34, v32, v34
    v_mul_f32 v36, v35, v36
    v_mul_f32 v37, v35, v37
    v_mul_f32 v39, v38, v39
    v_mul_f32 v40, v38, v40
    v_mul_f32 v42, v41, v42
    v_mul_f32 v43, v41, v43
    v_mul_f32 v44, v147, v34
    v_mul_f32 v45, v147, v33
    v_fma_f32 v44, v146, v33, -v44
    v_fma_f32 v45, -v146, v34, -v45
    v_cvt_pk_bf16_f32 v52, v44, v45
    v_cvt_pk_bf16_f32 v96, v36, v37
    v_cvt_pk_bf16_f32 v104, v39, v40
    v_cvt_pk_bf16_f32 v112, v42, v43
    v_lshlrev_b32 v46, 16, v52
    v_and_b32 v47, 0xffff0000, v52
    v_sub_f32 v44, v44, v46
    v_sub_f32 v45, v45, v47
    v_cvt_pk_bf16_f32 v56, v44, v45
    v_lshlrev_b32 v48, 16, v96
    v_and_b32 v49, 0xffff0000, v96
    v_sub_f32 v36, v36, v48
    v_sub_f32 v37, v37, v49
    v_cvt_pk_bf16_f32 v100, v36, v37
    v_lshlrev_b32 v46, 16, v104
    v_and_b32 v47, 0xffff0000, v104
    v_sub_f32 v39, v39, v46
    v_sub_f32 v40, v40, v47
    v_cvt_pk_bf16_f32 v108, v39, v40
    v_lshlrev_b32 v48, 16, v112
    v_and_b32 v49, 0xffff0000, v112
    v_sub_f32 v42, v42, v48
    v_sub_f32 v43, v43, v49
    v_cvt_pk_bf16_f32 v116, v42, v43
    v_mul_f32 v32, v148, v27
    v_mul_f32 v33, v149, v27
    v_mul_f32 v35, v148, v24
    v_mul_f32 v36, v149, v24
    v_mul_f32 v38, v148, v25
    v_mul_f32 v39, v149, v25
    v_mul_f32 v41, v148, v26
    v_mul_f32 v42, v149, v26
    v_exp_f32 v32, v32
    v_fract_f32 v33, v33
    v_exp_f32 v35, v35
    v_fract_f32 v36, v36
    v_exp_f32 v38, v38
    v_fract_f32 v39, v39
    v_exp_f32 v41, v41
    v_fract_f32 v42, v42
    v_sin_f32 v34, v33
    v_cos_f32 v33, v33
    v_sin_f32 v37, v36
    v_cos_f32 v36, v36
    v_sin_f32 v40, v39
    v_cos_f32 v39, v39
    v_sin_f32 v43, v42
    v_cos_f32 v42, v42
    v_mul_f32 v33, v32, v33
    v_mul_f32 v34, v32, v34
    v_mul_f32 v36, v35, v36
    v_mul_f32 v37, v35, v37
    v_mul_f32 v39, v38, v39
    v_mul_f32 v40, v38, v40
    v_mul_f32 v42, v41, v42
    v_mul_f32 v43, v41, v43
    v_mul_f32 v44, v151, v34
    v_mul_f32 v45, v151, v33
    v_fma_f32 v44, v150, v33, -v44
    v_fma_f32 v45, -v150, v34, -v45
    v_cvt_pk_bf16_f32 v53, v44, v45
    v_cvt_pk_bf16_f32 v97, v36, v37
    v_cvt_pk_bf16_f32 v105, v39, v40
    v_cvt_pk_bf16_f32 v113, v42, v43
    v_lshlrev_b32 v46, 16, v53
    v_and_b32 v47, 0xffff0000, v53
    v_sub_f32 v44, v44, v46
    v_sub_f32 v45, v45, v47
    v_cvt_pk_bf16_f32 v57, v44, v45
    v_lshlrev_b32 v48, 16, v97
    v_and_b32 v49, 0xffff0000, v97
    v_sub_f32 v36, v36, v48
    v_sub_f32 v37, v37, v49
    v_cvt_pk_bf16_f32 v101, v36, v37
    v_lshlrev_b32 v46, 16, v105
    v_and_b32 v47, 0xffff0000, v105
    v_sub_f32 v39, v39, v46
    v_sub_f32 v40, v40, v47
    v_cvt_pk_bf16_f32 v109, v39, v40
    v_lshlrev_b32 v48, 16, v113
    v_and_b32 v49, 0xffff0000, v113
    v_sub_f32 v42, v42, v48
    v_sub_f32 v43, v43, v49
    v_cvt_pk_bf16_f32 v117, v42, v43
    v_mul_f32 v32, v152, v27
    v_mul_f32 v33, v153, v27
    v_mul_f32 v35, v152, v24
    v_mul_f32 v36, v153, v24
    v_mul_f32 v38, v152, v25
    v_mul_f32 v39, v153, v25
    v_mul_f32 v41, v152, v26
    v_mul_f32 v42, v153, v26
    v_exp_f32 v32, v32
    v_fract_f32 v33, v33
    v_exp_f32 v35, v35
    v_fract_f32 v36, v36
    v_exp_f32 v38, v38
    v_fract_f32 v39, v39
    v_exp_f32 v41, v41
    v_fract_f32 v42, v42
    v_sin_f32 v34, v33
    v_cos_f32 v33, v33
    v_sin_f32 v37, v36
    v_cos_f32 v36, v36
    v_sin_f32 v40, v39
    v_cos_f32 v39, v39
    v_sin_f32 v43, v42
    v_cos_f32 v42, v42
    v_mul_f32 v33, v32, v33
    v_mul_f32 v34, v32, v34
    v_mul_f32 v36, v35, v36
    v_mul_f32 v37, v35, v37
    v_mul_f32 v39, v38, v39
    v_mul_f32 v40, v38, v40
    v_mul_f32 v42, v41, v42
    v_mul_f32 v43, v41, v43
    v_mul_f32 v44, v155, v34
    v_mul_f32 v45, v155, v33
    v_fma_f32 v44, v154, v33, -v44
    v_fma_f32 v45, -v154, v34, -v45
    v_cvt_pk_bf16_f32 v54, v44, v45
    v_cvt_pk_bf16_f32 v98, v36, v37
    v_cvt_pk_bf16_f32 v106, v39, v40
    v_cvt_pk_bf16_f32 v114, v42, v43
    v_lshlrev_b32 v46, 16, v54
    v_and_b32 v47, 0xffff0000, v54
    v_sub_f32 v44, v44, v46
    v_sub_f32 v45, v45, v47
    v_cvt_pk_bf16_f32 v58, v44, v45
    v_lshlrev_b32 v48, 16, v98
    v_and_b32 v49, 0xffff0000, v98
    v_sub_f32 v36, v36, v48
    v_sub_f32 v37, v37, v49
    v_cvt_pk_bf16_f32 v102, v36, v37
    v_lshlrev_b32 v46, 16, v106
    v_and_b32 v47, 0xffff0000, v106
    v_sub_f32 v39, v39, v46
    v_sub_f32 v40, v40, v47
    v_cvt_pk_bf16_f32 v110, v39, v40
    v_lshlrev_b32 v48, 16, v114
    v_and_b32 v49, 0xffff0000, v114
    v_sub_f32 v42, v42, v48
    v_sub_f32 v43, v43, v49
    v_cvt_pk_bf16_f32 v118, v42, v43
    s_waitcnt lgkmcnt(4)
    v_mul_f32 v32, v156, v27
    v_mul_f32 v33, v157, v27
    v_mul_f32 v35, v156, v24
    v_mul_f32 v36, v157, v24
    v_mul_f32 v38, v156, v25
    v_mul_f32 v39, v157, v25
    v_mul_f32 v41, v156, v26
    v_mul_f32 v42, v157, v26
    v_exp_f32 v32, v32
    v_fract_f32 v33, v33
    v_exp_f32 v35, v35
    v_fract_f32 v36, v36
    v_exp_f32 v38, v38
    v_fract_f32 v39, v39
    v_exp_f32 v41, v41
    v_fract_f32 v42, v42
    v_sin_f32 v34, v33
    v_cos_f32 v33, v33
    v_sin_f32 v37, v36
    v_cos_f32 v36, v36
    v_sin_f32 v40, v39
    v_cos_f32 v39, v39
    v_sin_f32 v43, v42
    v_cos_f32 v42, v42
    v_mul_f32 v33, v32, v33
    v_mul_f32 v34, v32, v34
    v_mul_f32 v36, v35, v36
    v_mul_f32 v37, v35, v37
    v_mul_f32 v39, v38, v39
    v_mul_f32 v40, v38, v40
    v_mul_f32 v42, v41, v42
    v_mul_f32 v43, v41, v43
    v_mul_f32 v44, v159, v34
    v_mul_f32 v45, v159, v33
    v_fma_f32 v44, v158, v33, -v44
    v_fma_f32 v45, -v158, v34, -v45
    v_cvt_pk_bf16_f32 v55, v44, v45
    v_cvt_pk_bf16_f32 v99, v36, v37
    v_cvt_pk_bf16_f32 v107, v39, v40
    v_cvt_pk_bf16_f32 v115, v42, v43
    v_lshlrev_b32 v46, 16, v55
    v_and_b32 v47, 0xffff0000, v55
    v_sub_f32 v44, v44, v46
    v_sub_f32 v45, v45, v47
    v_cvt_pk_bf16_f32 v59, v44, v45
    v_lshlrev_b32 v48, 16, v99
    v_and_b32 v49, 0xffff0000, v99
    v_sub_f32 v36, v36, v48
    v_sub_f32 v37, v37, v49
    v_cvt_pk_bf16_f32 v103, v36, v37
    v_lshlrev_b32 v46, 16, v107
    v_and_b32 v47, 0xffff0000, v107
    v_sub_f32 v39, v39, v46
    v_sub_f32 v40, v40, v47
    v_cvt_pk_bf16_f32 v111, v39, v40
    v_lshlrev_b32 v48, 16, v115
    v_and_b32 v49, 0xffff0000, v115
    v_sub_f32 v42, v42, v48
    v_sub_f32 v43, v43, v49
    v_cvt_pk_bf16_f32 v119, v42, v43
    v_mfma_f32_16x16x32_bf16 v[64:67], v[100:103], v[52:55], v[64:67]
    v_mfma_f32_16x16x32_bf16 v[64:67], v[96:99], v[56:59], v[64:67]
    v_mfma_f32_16x16x32_bf16 v[64:67], v[96:99], v[52:55], v[64:67]
    v_mfma_f32_16x16x32_bf16 v[68:71], v[108:111], v[52:55], v[68:71]
    v_mfma_f32_16x16x32_bf16 v[68:71], v[104:107], v[56:59], v[68:71]
    v_mfma_f32_16x16x32_bf16 v[68:71], v[104:107], v[52:55], v[68:71]
    v_mfma_f32_16x16x32_bf16 v[72:75], v[116:119], v[52:55], v[72:75]
    v_mfma_f32_16x16x32_bf16 v[72:75], v[112:115], v[56:59], v[72:75]
    v_mfma_f32_16x16x32_bf16 v[72:75], v[112:115], v[52:55], v[72:75]
    v_mul_f32 v32, v160, v27
    v_mul_f32 v33, v161, v27
    v_mul_f32 v35, v160, v24
    v_mul_f32 v36, v161, v24
    v_mul_f32 v38, v160, v25
    v_mul_f32 v39, v161, v25
    v_mul_f32 v41, v160, v26
    v_mul_f32 v42, v161, v26
    v_exp_f32 v32, v32
    v_fract_f32 v33, v33
    v_exp_f32 v35, v35
    v_fract_f32 v36, v36
    v_exp_f32 v38, v38
    v_fract_f32 v39, v39
    v_exp_f32 v41, v41
    v_fract_f32 v42, v42
    v_sin_f32 v34, v33
    v_cos_f32 v33, v33
    v_sin_f32 v37, v36
    v_cos_f32 v36, v36
    v_sin_f32 v40, v39
    v_cos_f32 v39, v39
    v_sin_f32 v43, v42
    v_cos_f32 v42, v42
    v_mul_f32 v33, v32, v33
    v_mul_f32 v34, v32, v34
    v_mul_f32 v36, v35, v36
    v_mul_f32 v37, v35, v37
    v_mul_f32 v39, v38, v39
    v_mul_f32 v40, v38, v40
    v_mul_f32 v42, v41, v42
    v_mul_f32 v43, v41, v43
    v_mul_f32 v44, v163, v34
    v_mul_f32 v45, v163, v33
    v_fma_f32 v44, v162, v33, -v44
    v_fma_f32 v45, -v162, v34, -v45
    v_cvt_pk_bf16_f32 v52, v44, v45
    v_cvt_pk_bf16_f32 v96, v36, v37
    v_cvt_pk_bf16_f32 v104, v39, v40
    v_cvt_pk_bf16_f32 v112, v42, v43
    v_lshlrev_b32 v46, 16, v52
    v_and_b32 v47, 0xffff0000, v52
    v_sub_f32 v44, v44, v46
    v_sub_f32 v45, v45, v47
    v_cvt_pk_bf16_f32 v56, v44, v45
    v_lshlrev_b32 v48, 16, v96
    v_and_b32 v49, 0xffff0000, v96
    v_sub_f32 v36, v36, v48
    v_sub_f32 v37, v37, v49
    v_cvt_pk_bf16_f32 v100, v36, v37
    v_lshlrev_b32 v46, 16, v104
    v_and_b32 v47, 0xffff0000, v104
    v_sub_f32 v39, v39, v46
    v_sub_f32 v40, v40, v47
    v_cvt_pk_bf16_f32 v108, v39, v40
    v_lshlrev_b32 v48, 16, v112
    v_and_b32 v49, 0xffff0000, v112
    v_sub_f32 v42, v42, v48
    v_sub_f32 v43, v43, v49
    v_cvt_pk_bf16_f32 v116, v42, v43
    v_mul_f32 v32, v164, v27
    v_mul_f32 v33, v165, v27
    v_mul_f32 v35, v164, v24
    v_mul_f32 v36, v165, v24
    v_mul_f32 v38, v164, v25
    v_mul_f32 v39, v165, v25
    v_mul_f32 v41, v164, v26
    v_mul_f32 v42, v165, v26
    v_exp_f32 v32, v32
    v_fract_f32 v33, v33
    v_exp_f32 v35, v35
    v_fract_f32 v36, v36
    v_exp_f32 v38, v38
    v_fract_f32 v39, v39
    v_exp_f32 v41, v41
    v_fract_f32 v42, v42
    v_sin_f32 v34, v33
    v_cos_f32 v33, v33
    v_sin_f32 v37, v36
    v_cos_f32 v36, v36
    v_sin_f32 v40, v39
    v_cos_f32 v39, v39
    v_sin_f32 v43, v42
    v_cos_f32 v42, v42
    v_mul_f32 v33, v32, v33
    v_mul_f32 v34, v32, v34
    v_mul_f32 v36, v35, v36
    v_mul_f32 v37, v35, v37
    v_mul_f32 v39, v38, v39
    v_mul_f32 v40, v38, v40
    v_mul_f32 v42, v41, v42
    v_mul_f32 v43, v41, v43
    v_mul_f32 v44, v167, v34
    v_mul_f32 v45, v167, v33
    v_fma_f32 v44, v166, v33, -v44
    v_fma_f32 v45, -v166, v34, -v45
    v_cvt_pk_bf16_f32 v53, v44, v45
    v_cvt_pk_bf16_f32 v97, v36, v37
    v_cvt_pk_bf16_f32 v105, v39, v40
    v_cvt_pk_bf16_f32 v113, v42, v43
    v_lshlrev_b32 v46, 16, v53
    v_and_b32 v47, 0xffff0000, v53
    v_sub_f32 v44, v44, v46
    v_sub_f32 v45, v45, v47
    v_cvt_pk_bf16_f32 v57, v44, v45
    v_lshlrev_b32 v48, 16, v97
    v_and_b32 v49, 0xffff0000, v97
    v_sub_f32 v36, v36, v48
    v_sub_f32 v37, v37, v49
    v_cvt_pk_bf16_f32 v101, v36, v37
    v_lshlrev_b32 v46, 16, v105
    v_and_b32 v47, 0xffff0000, v105
    v_sub_f32 v39, v39, v46
    v_sub_f32 v40, v40, v47
    v_cvt_pk_bf16_f32 v109, v39, v40
    v_lshlrev_b32 v48, 16, v113
    v_and_b32 v49, 0xffff0000, v113
    v_sub_f32 v42, v42, v48
    v_sub_f32 v43, v43, v49
    v_cvt_pk_bf16_f32 v117, v42, v43
    v_mul_f32 v32, v168, v27
    v_mul_f32 v33, v169, v27
    v_mul_f32 v35, v168, v24
    v_mul_f32 v36, v169, v24
    v_mul_f32 v38, v168, v25
    v_mul_f32 v39, v169, v25
    v_mul_f32 v41, v168, v26
    v_mul_f32 v42, v169, v26
    v_exp_f32 v32, v32
    v_fract_f32 v33, v33
    v_exp_f32 v35, v35
    v_fract_f32 v36, v36
    v_exp_f32 v38, v38
    v_fract_f32 v39, v39
    v_exp_f32 v41, v41
    v_fract_f32 v42, v42
    v_sin_f32 v34, v33
    v_cos_f32 v33, v33
    v_sin_f32 v37, v36
    v_cos_f32 v36, v36
    v_sin_f32 v40, v39
    v_cos_f32 v39, v39
    v_sin_f32 v43, v42
    v_cos_f32 v42, v42
    v_mul_f32 v33, v32, v33
    v_mul_f32 v34, v32, v34
    v_mul_f32 v36, v35, v36
    v_mul_f32 v37, v35, v37
    v_mul_f32 v39, v38, v39
    v_mul_f32 v40, v38, v40
    v_mul_f32 v42, v41, v42
    v_mul_f32 v43, v41, v43
    v_mul_f32 v44, v171, v34
    v_mul_f32 v45, v171, v33
    v_fma_f32 v44, v170, v33, -v44
    v_fma_f32 v45, -v170, v34, -v45
    v_cvt_pk_bf16_f32 v54, v44, v45
    v_cvt_pk_bf16_f32 v98, v36, v37
    v_cvt_pk_bf16_f32 v106, v39, v40
    v_cvt_pk_bf16_f32 v114, v42, v43
    v_lshlrev_b32 v46, 16, v54
    v_and_b32 v47, 0xffff0000, v54
    v_sub_f32 v44, v44, v46
    v_sub_f32 v45, v45, v47
    v_cvt_pk_bf16_f32 v58, v44, v45
    v_lshlrev_b32 v48, 16, v98
    v_and_b32 v49, 0xffff0000, v98
    v_sub_f32 v36, v36, v48
    v_sub_f32 v37, v37, v49
    v_cvt_pk_bf16_f32 v102, v36, v37
    v_lshlrev_b32 v46, 16, v106
    v_and_b32 v47, 0xffff0000, v106
    v_sub_f32 v39, v39, v46
    v_sub_f32 v40, v40, v47
    v_cvt_pk_bf16_f32 v110, v39, v40
    v_lshlrev_b32 v48, 16, v114
    v_and_b32 v49, 0xffff0000, v114
    v_sub_f32 v42, v42, v48
    v_sub_f32 v43, v43, v49
    v_cvt_pk_bf16_f32 v118, v42, v43
    s_waitcnt lgkmcnt(0)
    v_mul_f32 v32, v172, v27
    v_mul_f32 v33, v173, v27
    v_mul_f32 v35, v172, v24
    v_mul_f32 v36, v173, v24
    v_mul_f32 v38, v172, v25
    v_mul_f32 v39, v173, v25
    v_mul_f32 v41, v172, v26
    v_mul_f32 v42, v173, v26
    v_exp_f32 v32, v32
    v_fract_f32 v33, v33
    v_exp_f32 v35, v35
    v_fract_f32 v36, v36
    v_exp_f32 v38, v38
    v_fract_f32 v39, v39
    v_exp_f32 v41, v41
    v_fract_f32 v42, v42
    v_sin_f32 v34, v33
    v_cos_f32 v33, v33
    v_sin_f32 v37, v36
    v_cos_f32 v36, v36
    v_sin_f32 v40, v39
    v_cos_f32 v39, v39
    v_sin_f32 v43, v42
    v_cos_f32 v42, v42
    v_mul_f32 v33, v32, v33
    v_mul_f32 v34, v32, v34
    v_mul_f32 v36, v35, v36
    v_mul_f32 v37, v35, v37
    v_mul_f32 v39, v38, v39
    v_mul_f32 v40, v38, v40
    v_mul_f32 v42, v41, v42
    v_mul_f32 v43, v41, v43
    v_mul_f32 v44, v175, v34
    v_mul_f32 v45, v175, v33
    v_fma_f32 v44, v174, v33, -v44
    v_fma_f32 v45, -v174, v34, -v45
    v_cvt_pk_bf16_f32 v55, v44, v45
    v_cvt_pk_bf16_f32 v99, v36, v37
    v_cvt_pk_bf16_f32 v107, v39, v40
    v_cvt_pk_bf16_f32 v115, v42, v43
    v_lshlrev_b32 v46, 16, v55
    v_and_b32 v47, 0xffff0000, v55
    v_sub_f32 v44, v44, v46
    v_sub_f32 v45, v45, v47
    v_cvt_pk_bf16_f32 v59, v44, v45
    v_lshlrev_b32 v48, 16, v99
    v_and_b32 v49, 0xffff0000, v99
    v_sub_f32 v36, v36, v48
    v_sub_f32 v37, v37, v49
    v_cvt_pk_bf16_f32 v103, v36, v37
    v_lshlrev_b32 v46, 16, v107
    v_and_b32 v47, 0xffff0000, v107
    v_sub_f32 v39, v39, v46
    v_sub_f32 v40, v40, v47
    v_cvt_pk_bf16_f32 v111, v39, v40
    v_lshlrev_b32 v48, 16, v115
    v_and_b32 v49, 0xffff0000, v115
    v_sub_f32 v42, v42, v48
    v_sub_f32 v43, v43, v49
    v_cvt_pk_bf16_f32 v119, v42, v43
    v_mfma_f32_16x16x32_bf16 v[64:67], v[100:103], v[52:55], v[64:67]
    v_mfma_f32_16x16x32_bf16 v[64:67], v[96:99], v[56:59], v[64:67]
    v_mfma_f32_16x16x32_bf16 v[64:67], v[96:99], v[52:55], v[64:67]
    v_mfma_f32_16x16x32_bf16 v[68:71], v[108:111], v[52:55], v[68:71]
    v_mfma_f32_16x16x32_bf16 v[68:71], v[104:107], v[56:59], v[68:71]
    v_mfma_f32_16x16x32_bf16 v[68:71], v[104:107], v[52:55], v[68:71]
    v_mfma_f32_16x16x32_bf16 v[72:75], v[116:119], v[52:55], v[72:75]
    v_mfma_f32_16x16x32_bf16 v[72:75], v[112:115], v[56:59], v[72:75]
    v_mfma_f32_16x16x32_bf16 v[72:75], v[112:115], v[52:55], v[72:75]
    v_mul_f32 v32, v176, v27
    v_mul_f32 v33, v177, v27
    v_mul_f32 v35, v176, v24
    v_mul_f32 v36, v177, v24
    v_mul_f32 v38, v176, v25
    v_mul_f32 v39, v177, v25
    v_mul_f32 v41, v176, v26
    v_mul_f32 v42, v177, v26
    v_exp_f32 v32, v32
    v_fract_f32 v33, v33
    v_exp_f32 v35, v35
    v_fract_f32 v36, v36
    v_exp_f32 v38, v38
    v_fract_f32 v39, v39
    v_exp_f32 v41, v41
    v_fract_f32 v42, v42
    v_sin_f32 v34, v33
    v_cos_f32 v33, v33
    v_sin_f32 v37, v36
    v_cos_f32 v36, v36
    v_sin_f32 v40, v39
    v_cos_f32 v39, v39
    v_sin_f32 v43, v42
    v_cos_f32 v42, v42
    v_mul_f32 v33, v32, v33
    v_mul_f32 v34, v32, v34
    v_mul_f32 v36, v35, v36
    v_mul_f32 v37, v35, v37
    v_mul_f32 v39, v38, v39
    v_mul_f32 v40, v38, v40
    v_mul_f32 v42, v41, v42
    v_mul_f32 v43, v41, v43
    v_mul_f32 v44, v179, v34
    v_mul_f32 v45, v179, v33
    v_fma_f32 v44, v178, v33, -v44
    v_fma_f32 v45, -v178, v34, -v45
    v_cvt_pk_bf16_f32 v52, v44, v45
    v_cvt_pk_bf16_f32 v96, v36, v37
    v_cvt_pk_bf16_f32 v104, v39, v40
    v_cvt_pk_bf16_f32 v112, v42, v43
    v_lshlrev_b32 v46, 16, v52
    v_and_b32 v47, 0xffff0000, v52
    v_sub_f32 v44, v44, v46
    v_sub_f32 v45, v45, v47
    v_cvt_pk_bf16_f32 v56, v44, v45
    v_lshlrev_b32 v48, 16, v96
    v_and_b32 v49, 0xffff0000, v96
    v_sub_f32 v36, v36, v48
    v_sub_f32 v37, v37, v49
    v_cvt_pk_bf16_f32 v100, v36, v37
    v_lshlrev_b32 v46, 16, v104
    v_and_b32 v47, 0xffff0000, v104
    v_sub_f32 v39, v39, v46
    v_sub_f32 v40, v40, v47
    v_cvt_pk_bf16_f32 v108, v39, v40
    v_lshlrev_b32 v48, 16, v112
    v_and_b32 v49, 0xffff0000, v112
    v_sub_f32 v42, v42, v48
    v_sub_f32 v43, v43, v49
    v_cvt_pk_bf16_f32 v116, v42, v43
    v_mul_f32 v32, v180, v27
    v_mul_f32 v33, v181, v27
    v_mul_f32 v35, v180, v24
    v_mul_f32 v36, v181, v24
    v_mul_f32 v38, v180, v25
    v_mul_f32 v39, v181, v25
    v_mul_f32 v41, v180, v26
    v_mul_f32 v42, v181, v26
    v_exp_f32 v32, v32
    v_fract_f32 v33, v33
    v_exp_f32 v35, v35
    v_fract_f32 v36, v36
    v_exp_f32 v38, v38
    v_fract_f32 v39, v39
    v_exp_f32 v41, v41
    v_fract_f32 v42, v42
    v_sin_f32 v34, v33
    v_cos_f32 v33, v33
    v_sin_f32 v37, v36
    v_cos_f32 v36, v36
    v_sin_f32 v40, v39
    v_cos_f32 v39, v39
    v_sin_f32 v43, v42
    v_cos_f32 v42, v42
    v_mul_f32 v33, v32, v33
    v_mul_f32 v34, v32, v34
    v_mul_f32 v36, v35, v36
    v_mul_f32 v37, v35, v37
    v_mul_f32 v39, v38, v39
    v_mul_f32 v40, v38, v40
    v_mul_f32 v42, v41, v42
    v_mul_f32 v43, v41, v43
    v_mul_f32 v44, v183, v34
    v_mul_f32 v45, v183, v33
    v_fma_f32 v44, v182, v33, -v44
    v_fma_f32 v45, -v182, v34, -v45
    v_cvt_pk_bf16_f32 v53, v44, v45
    v_cvt_pk_bf16_f32 v97, v36, v37
    v_cvt_pk_bf16_f32 v105, v39, v40
    v_cvt_pk_bf16_f32 v113, v42, v43
    v_lshlrev_b32 v46, 16, v53
    v_and_b32 v47, 0xffff0000, v53
    v_sub_f32 v44, v44, v46
    v_sub_f32 v45, v45, v47
    v_cvt_pk_bf16_f32 v57, v44, v45
    v_lshlrev_b32 v48, 16, v97
    v_and_b32 v49, 0xffff0000, v97
    v_sub_f32 v36, v36, v48
    v_sub_f32 v37, v37, v49
    v_cvt_pk_bf16_f32 v101, v36, v37
    v_lshlrev_b32 v46, 16, v105
    v_and_b32 v47, 0xffff0000, v105
    v_sub_f32 v39, v39, v46
    v_sub_f32 v40, v40, v47
    v_cvt_pk_bf16_f32 v109, v39, v40
    v_lshlrev_b32 v48, 16, v113
    v_and_b32 v49, 0xffff0000, v113
    v_sub_f32 v42, v42, v48
    v_sub_f32 v43, v43, v49
    v_cvt_pk_bf16_f32 v117, v42, v43
    v_mul_f32 v32, v184, v27
    v_mul_f32 v33, v185, v27
    v_mul_f32 v35, v184, v24
    v_mul_f32 v36, v185, v24
    v_mul_f32 v38, v184, v25
    v_mul_f32 v39, v185, v25
    v_mul_f32 v41, v184, v26
    v_mul_f32 v42, v185, v26
    v_exp_f32 v32, v32
    v_fract_f32 v33, v33
    v_exp_f32 v35, v35
    v_fract_f32 v36, v36
    v_exp_f32 v38, v38
    v_fract_f32 v39, v39
    v_exp_f32 v41, v41
    v_fract_f32 v42, v42
    v_sin_f32 v34, v33
    v_cos_f32 v33, v33
    v_sin_f32 v37, v36
    v_cos_f32 v36, v36
    v_sin_f32 v40, v39
    v_cos_f32 v39, v39
    v_sin_f32 v43, v42
    v_cos_f32 v42, v42
    v_mul_f32 v33, v32, v33
    v_mul_f32 v34, v32, v34
    v_mul_f32 v36, v35, v36
    v_mul_f32 v37, v35, v37
    v_mul_f32 v39, v38, v39
    v_mul_f32 v40, v38, v40
    v_mul_f32 v42, v41, v42
    v_mul_f32 v43, v41, v43
    v_mul_f32 v44, v187, v34
    v_mul_f32 v45, v187, v33
    v_fma_f32 v44, v186, v33, -v44
    v_fma_f32 v45, -v186, v34, -v45
    v_cvt_pk_bf16_f32 v54, v44, v45
    v_cvt_pk_bf16_f32 v98, v36, v37
    v_cvt_pk_bf16_f32 v106, v39, v40
    v_cvt_pk_bf16_f32 v114, v42, v43
    v_lshlrev_b32 v46, 16, v54
    v_and_b32 v47, 0xffff0000, v54
    v_sub_f32 v44, v44, v46
    v_sub_f32 v45, v45, v47
    v_cvt_pk_bf16_f32 v58, v44, v45
    v_lshlrev_b32 v48, 16, v98
    v_and_b32 v49, 0xffff0000, v98
    v_sub_f32 v36, v36, v48
    v_sub_f32 v37, v37, v49
    v_cvt_pk_bf16_f32 v102, v36, v37
    v_lshlrev_b32 v46, 16, v106
    v_and_b32 v47, 0xffff0000, v106
    v_sub_f32 v39, v39, v46
    v_sub_f32 v40, v40, v47
    v_cvt_pk_bf16_f32 v110, v39, v40
    v_lshlrev_b32 v48, 16, v114
    v_and_b32 v49, 0xffff0000, v114
    v_sub_f32 v42, v42, v48
    v_sub_f32 v43, v43, v49
    v_cvt_pk_bf16_f32 v118, v42, v43
    v_mul_f32 v32, v188, v27
    v_mul_f32 v33, v189, v27
    v_mul_f32 v35, v188, v24
    v_mul_f32 v36, v189, v24
    v_mul_f32 v38, v188, v25
    v_mul_f32 v39, v189, v25
    v_mul_f32 v41, v188, v26
    v_mul_f32 v42, v189, v26
    v_exp_f32 v32, v32
    v_fract_f32 v33, v33
    v_exp_f32 v35, v35
    v_fract_f32 v36, v36
    v_exp_f32 v38, v38
    v_fract_f32 v39, v39
    v_exp_f32 v41, v41
    v_fract_f32 v42, v42
    v_sin_f32 v34, v33
    v_cos_f32 v33, v33
    v_sin_f32 v37, v36
    v_cos_f32 v36, v36
    v_sin_f32 v40, v39
    v_cos_f32 v39, v39
    v_sin_f32 v43, v42
    v_cos_f32 v42, v42
    v_mul_f32 v33, v32, v33
    v_mul_f32 v34, v32, v34
    v_mul_f32 v36, v35, v36
    v_mul_f32 v37, v35, v37
    v_mul_f32 v39, v38, v39
    v_mul_f32 v40, v38, v40
    v_mul_f32 v42, v41, v42
    v_mul_f32 v43, v41, v43
    v_mul_f32 v44, v191, v34
    v_mul_f32 v45, v191, v33
    v_fma_f32 v44, v190, v33, -v44
    v_fma_f32 v45, -v190, v34, -v45
    v_cvt_pk_bf16_f32 v55, v44, v45
    v_cvt_pk_bf16_f32 v99, v36, v37
    v_cvt_pk_bf16_f32 v107, v39, v40
    v_cvt_pk_bf16_f32 v115, v42, v43
    v_lshlrev_b32 v46, 16, v55
    v_and_b32 v47, 0xffff0000, v55
    v_sub_f32 v44, v44, v46
    v_sub_f32 v45, v45, v47
    v_cvt_pk_bf16_f32 v59, v44, v45
    v_lshlrev_b32 v48, 16, v99
    v_and_b32 v49, 0xffff0000, v99
    v_sub_f32 v36, v36, v48
    v_sub_f32 v37, v37, v49
    v_cvt_pk_bf16_f32 v103, v36, v37
    v_lshlrev_b32 v46, 16, v107
    v_and_b32 v47, 0xffff0000, v107
    v_sub_f32 v39, v39, v46
    v_sub_f32 v40, v40, v47
    v_cvt_pk_bf16_f32 v111, v39, v40
    v_lshlrev_b32 v48, 16, v115
    v_and_b32 v49, 0xffff0000, v115
    v_sub_f32 v42, v42, v48
    v_sub_f32 v43, v43, v49
    v_cvt_pk_bf16_f32 v119, v42, v43
    v_mfma_f32_16x16x32_bf16 v[64:67], v[100:103], v[52:55], v[64:67]
    v_mfma_f32_16x16x32_bf16 v[64:67], v[96:99], v[56:59], v[64:67]
    v_mfma_f32_16x16x32_bf16 v[64:67], v[96:99], v[52:55], v[64:67]
    v_mfma_f32_16x16x32_bf16 v[68:71], v[108:111], v[52:55], v[68:71]
    v_mfma_f32_16x16x32_bf16 v[68:71], v[104:107], v[56:59], v[68:71]
    v_mfma_f32_16x16x32_bf16 v[68:71], v[104:107], v[52:55], v[68:71]
    v_mfma_f32_16x16x32_bf16 v[72:75], v[116:119], v[52:55], v[72:75]
    v_mfma_f32_16x16x32_bf16 v[72:75], v[112:115], v[56:59], v[72:75]
    v_mfma_f32_16x16x32_bf16 v[72:75], v[112:115], v[52:55], v[72:75]
    s_mul_i32 s21, s16, 3072
    s_add_u32 s21, s21, 34432
    v_add_u32 v9, s21, v7
    ds_write_b128 v9, v[64:67] offset:0
    s_nop 0
    ds_write_b128 v9, v[68:71] offset:1024
    s_nop 1
    ds_write_b128 v9, v[72:75] offset:2048
    s_xor_b32 s21, s16, 1
    s_mul_i32 s21, s21, 3072
    s_add_u32 s21, s21, 34432
    v_add_u32 v9, s21, v7
    s_mul_i32 s47, s32, 12288
    s_add_u32 s47, s47, 50816
    v_lshlrev_b32 v10, 4, v4
    v_lshlrev_b32 v11, 3, v3
    s_waitcnt lgkmcnt(0)
    s_barrier
    s_cmp_eq_u32 s31, 0
    s_cbranch_scc0 K2_c1
    ds_read_b128 v[40:43], v9 offset:0
    ds_read_b128 v[48:51], v10 offset:0
    ds_read_b128 v[44:47], v9 offset:1024
    ds_read_b128 v[52:55], v10 offset:64
    s_waitcnt lgkmcnt(0)
    v_add_f32 v40, v40, v64
    v_add_u32 v48, v48, v11
    v_lshl_add_u32 v48, v48, 2, s47
    ds_write_b32 v48, v40
    v_add_f32 v41, v41, v65
    v_add_u32 v49, v49, v11
    v_lshl_add_u32 v49, v49, 2, s47
    ds_write_b32 v49, v41
    v_add_f32 v42, v42, v66
    v_add_u32 v50, v50, v11
    v_lshl_add_u32 v50, v50, 2, s47
    ds_write_b32 v50, v42
    v_add_f32 v43, v43, v67
    v_add_u32 v51, v51, v11
    v_lshl_add_u32 v51, v51, 2, s47
    ds_write_b32 v51, v43
    v_add_f32 v44, v44, v68
    v_add_u32 v52, v52, v11
    v_lshl_add_u32 v52, v52, 2, s47
    ds_write_b32 v52, v44
    v_add_f32 v45, v45, v69
    v_add_u32 v53, v53, v11
    v_lshl_add_u32 v53, v53, 2, s47
    ds_write_b32 v53, v45
    v_add_f32 v46, v46, v70
    v_add_u32 v54, v54, v11
    v_lshl_add_u32 v54, v54, 2, s47
    ds_write_b32 v54, v46
    v_add_f32 v47, v47, v71
    v_add_u32 v55, v55, v11
    v_lshl_add_u32 v55, v55, 2, s47
    ds_write_b32 v55, v47
    v_max_f32 v56, |v40|, |v41|
    v_max_f32 v57, |v42|, |v43|
    v_max_f32 v56, v56, v57
    v_max_f32 v57, |v44|, |v45|
    v_max_f32 v58, |v46|, |v47|
    v_max3_f32 v56, v56, v57, v58
    s_nop 1
    v_max_f32_dpp v56, v56, v56 quad_perm:[1,0,3,2] row_mask:0xf bank_mask:0xf
    s_nop 1
    v_max_f32_dpp v56, v56, v56 quad_perm:[2,3,0,1] row_mask:0xf bank_mask:0xf
    s_nop 1
    v_max_f32_dpp v56, v56, v56 row_half_mirror row_mask:0xf bank_mask:0xf
    s_nop 1
    v_max_f32_dpp v56, v56, v56 row_mirror row_mask:0xf bank_mask:0xf
    ds_max_f32 v31, v56 offset:192
    s_branch K2_c2
K2_c1:
    ds_read_b128 v[40:43], v9 offset:2048
    ds_read_b128 v[48:51], v10 offset:128
    s_waitcnt lgkmcnt(0)
    v_add_f32 v40, v40, v72
    v_add_u32 v48, v48, v11
    v_lshl_add_u32 v48, v48, 2, s47
    ds_write_b32 v48, v40
    v_add_f32 v41, v41, v73
    v_add_u32 v49, v49, v11
    v_lshl_add_u32 v49, v49, 2, s47
    ds_write_b32 v49, v41
    v_add_f32 v42, v42, v74
    v_add_u32 v50, v50, v11
    v_lshl_add_u32 v50, v50, 2, s47
    ds_write_b32 v50, v42
    v_add_f32 v43, v43, v75
    v_add_u32 v51, v51, v11
    v_lshl_add_u32 v51, v51, 2, s47
    ds_write_b32 v51, v43
    v_max_f32 v56, |v40|, |v41|
    v_max_f32 v57, |v42|, |v43|
    v_max_f32 v56, v56, v57
    s_nop 1
    v_max_f32_dpp v56, v56, v56 quad_perm:[1,0,3,2] row_mask:0xf bank_mask:0xf
    s_nop 1
    v_max_f32_dpp v56, v56, v56 quad_perm:[2,3,0,1] row_mask:0xf bank_mask:0xf
    s_nop 1
    v_max_f32_dpp v56, v56, v56 row_half_mirror row_mask:0xf bank_mask:0xf
    s_nop 1
    v_max_f32_dpp v56, v56, v56 row_mirror row_mask:0xf bank_mask:0xf
    ds_max_f32 v31, v56 offset:192
K2_c2:
    s_waitcnt lgkmcnt(0)
    s_barrier
    ds_read_b32 v56, v31 offset:192
    v_and_b32 v12, 0x7f, v0
    ds_read_b32 v32, v192
    ds_read_b32 v33, v193
    ds_read_b32 v34, v194
    ds_read_b32 v35, v195
    ds_read_b32 v36, v196
    ds_read_b32 v37, v197
    ds_read_b32 v38, v198
    ds_read_b32 v39, v199
    ds_read_b32 v40, v200
    ds_read_b32 v41, v201
    ds_read_b32 v42, v202
    s_waitcnt lgkmcnt(6)
    ds_read_b32 v43, v203
    ds_read_b32 v44, v204
    ds_read_b32 v45, v205
    ds_read_b32 v46, v206
    ds_read_b32 v47, v207
    s_waitcnt lgkmcnt(0)
    v_bfe_u32 v56, v56, 23, 8
    v_max_u32 v56, 20, v56
    v_min_u32 v56, 0xfe, v56
    v_sub_u32 v57, 0x10c, v56
    v_lshlrev_b32 v57, 23, v57
    v_subrev_u32 v58, 14, v56
    v_lshlrev_b32 v58, 23, v58
    v_mul_f32 v32, v32, v57
    v_mul_f32 v33, v33, v57
    v_mul_f32 v34, v34, v57
    v_mul_f32 v35, v35, v57
    v_mul_f32 v36, v36, v57
    v_mul_f32 v37, v37, v57
    v_mul_f32 v38, v38, v57
    v_mul_f32 v39, v39, v57
    v_mul_f32 v40, v40, v57
    v_mul_f32 v41, v41, v57
    v_mul_f32 v42, v42, v57
    v_mul_f32 v43, v43, v57
    v_mul_f32 v44, v44, v57
    v_mul_f32 v45, v45, v57
    v_mul_f32 v46, v46, v57
    v_mul_f32 v47, v47, v57
    v_cvt_f16_f32 v32, v32
    v_cvt_f16_f32 v33, v33
    v_cvt_f16_f32 v34, v34
    v_cvt_f16_f32 v35, v35
    v_cvt_f16_f32 v36, v36
    v_cvt_f16_f32 v37, v37
    v_cvt_f16_f32 v38, v38
    v_cvt_f16_f32 v39, v39
    v_cvt_f16_f32 v40, v40
    v_cvt_f16_f32 v41, v41
    v_cvt_f16_f32 v42, v42
    v_cvt_f16_f32 v43, v43
    v_cvt_f16_f32 v44, v44
    v_cvt_f16_f32 v45, v45
    v_cvt_f16_f32 v46, v46
    v_cvt_f16_f32 v47, v47
    v_lshlrev_b32 v13, 2, v12
    s_mul_i32 s21, s33, 4160
    s_add_u32 s21, s21, 0x400000
    v_pack_b32_f16 v64, v32, v33
    buffer_store_dword v64, v13, s[8:11], s21 offen offset:32
    v_pack_b32_f16 v65, v34, v35
    buffer_store_dword v65, v13, s[8:11], s21 offen offset:544
    v_pack_b32_f16 v66, v36, v37
    buffer_store_dword v66, v13, s[8:11], s21 offen offset:1056
    v_pack_b32_f16 v67, v38, v39
    buffer_store_dword v67, v13, s[8:11], s21 offen offset:1568
    v_pack_b32_f16 v68, v40, v41
    buffer_store_dword v68, v13, s[8:11], s21 offen offset:2080
    v_pack_b32_f16 v69, v42, v43
    buffer_store_dword v69, v13, s[8:11], s21 offen offset:2592
    v_pack_b32_f16 v70, v44, v45
    buffer_store_dword v70, v13, s[8:11], s21 offen offset:3104
    v_pack_b32_f16 v71, v46, v47
    buffer_store_dword v71, v13, s[8:11], s21 offen offset:3616
    v_and_b32 v6, 1, v1
    v_lshlrev_b32 v6, 4, v6
    v_and_b32 v8, 2, v1
    v_mul_u32_u24 v8, 2064, v8
    v_add_u32 v6, v6, v8
    v_mov_b32 v19, 0
    s_cmp_lg_u32 s31, 0
    s_cbranch_scc1 K2_done
    s_mov_b64 exec, 0xf
    buffer_store_dwordx4 v[16:19], v6, s[8:11], s21 offen
    s_lshl_b32 s21, s33, 2
    s_add_u32 s21, s21, 0x680000
    s_mov_b64 exec, 1
    buffer_store_dword v58, v16, s[8:11], s21 offen
K2_done:
    s_endpgm
.section .rodata,"a"
.p2align 6
.amdhsa_kernel k2_kernel
  .amdhsa_next_free_vgpr 232
  .amdhsa_next_free_sgpr 96
  .amdhsa_accum_offset 232
  .amdhsa_group_segment_fixed_size 0
  .amdhsa_kernarg_size 112
  .amdhsa_user_sgpr_count 2
  .amdhsa_user_sgpr_kernarg_segment_ptr 1
  .amdhsa_system_sgpr_workgroup_id_x 1
  .amdhsa_float_denorm_mode_32 3
.end_amdhsa_kernel
.text
.globl k3_kernel
.p2align 8
.type k3_kernel,@function
k3_kernel:
    s_cmp_ge_u32 s2, 512
    s_cbranch_scc1 K3_done
    s_load_dwordx2 s[4:5], s[0:1], 104
    s_load_dwordx2 s[6:7], s[0:1], 96
    v_and_b32 v1, 63, v0
    v_lshrrev_b32 v2, 6, v0
    v_and_b32 v3, 15, v1
    v_lshrrev_b32 v4, 4, v1
    v_readfirstlane_b32 s16, v2
    v_lshlrev_b32 v7, 4, v1
    s_waitcnt lgkmcnt(0)
    s_mov_b32 s84, s6
    s_mov_b32 s85, s7
    s_mov_b32 s86, 256
    s_mov_b32 s87, 0x00020000
    s_cmp_lt_u32 s2, 256
    s_cbranch_scc1 K3_conv
    s_sub_u32 s2, s2, 256
    s_load_dwordx4 s[24:27], s[0:1], 80
    s_load_dwordx2 s[28:29], s[0:1], 0
    s_and_b32 s31, s2, 7
    s_lshr_b32 s32, s2, 3
    s_lshl_b32 s33, s31, 2
    s_and_b32 s34, s32, 3
    s_add_u32 s33, s33, s34
    s_lshr_b32 s34, s32, 2
    s_lshl_b32 s35, s33, 16
    s_lshl_b32 s36, s16, 14
    s_add_u32 s35, s35, s36
    s_lshl_b32 s36, s34, 7
    s_add_u32 s35, s35, s36
    v_lshlrev_b32 v6, 10, v3
    v_lshl_add_u32 v6, v4, 5, v6
    v_lshrrev_b32 v5, 3, v1
    v_and_b32 v8, 7, v1
    v_lshrrev_b32 v14, 1, v8
    v_xor_b32 v14, v14, v4
    v_and_b32 v14, 3, v14
    v_lshlrev_b32 v14, 1, v14
    v_and_b32 v15, 1, v8
    v_or_b32 v14, v14, v15
    v_lshlrev_b32 v10, 10, v5
    v_lshl_add_u32 v10, v14, 4, v10
    s_lshl_b32 s36, s34, 7
    v_add_u32 v10, s36, v10
    v_add_u32 v11, 8192, v10
    v_add_u32 v12, 16384, v10
    v_add_u32 v13, 24576, v10
    v_mov_b32 v16, v7
    v_add_u32 v17, 57344, v7
    v_add_u32 v18, 114688, v7
    v_add_u32 v19, 172032, v7
    s_mul_i32 s38, s16, 14
    s_lshl_b32 s39, s38, 15
    s_mul_i32 s40, s33, 224
    s_add_u32 s40, s40, s38
    s_lshl_b32 s40, s40, 10
    s_add_u32 s40, s40, 0x800000
    s_mul_i32 s41, s16, 20480
    s_waitcnt lgkmcnt(0)
    s_mov_b32 s8, s4
    s_mov_b32 s9, s5
    s_mov_b32 s10, 0x1200000
    s_mov_b32 s11, 0x00020000
    s_mov_b32 s12, s24
    s_mov_b32 s13, s25
    s_mov_b32 s14, 0x1c0000
    s_mov_b32 s15, 0x00020000
    s_mov_b32 s20, s26
    s_mov_b32 s21, s27
    s_mov_b32 s22, 0x200000
    s_mov_b32 s23, 0x00020000
    s_mov_b32 s44, s28
    s_mov_b32 s45, s29
    s_mov_b32 s46, 2097152
    s_mov_b32 s47, 0x00020000
    s_mov_b32 s49, 0
    s_add_u32 s51, s49, 0
    s_cmp_ge_u32 s51, 14
    s_cselect_b32 s50, 14, 0
    s_sub_u32 s51, s51, s50
    s_lshl_b32 s52, s51, 15
    s_add_u32 s52, s52, s39
    s_add_u32 s42, s41, 0
    s_mov_b32 m0, s42
    s_mov_b32 s43, s52
    buffer_load_dwordx4 v10, s[12:15], s43 offen lds
    s_add_u32 s42, s41, 1024
    s_mov_b32 m0, s42
    s_mov_b32 s43, s52
    buffer_load_dwordx4 v11, s[12:15], s43 offen lds
    s_add_u32 s42, s41, 2048
    s_mov_b32 m0, s42
    s_mov_b32 s43, s52
    buffer_load_dwordx4 v12, s[12:15], s43 offen lds
    s_add_u32 s42, s41, 3072
    s_mov_b32 m0, s42
    s_mov_b32 s43, s52
    buffer_load_dwordx4 v13, s[12:15], s43 offen lds
    s_add_u32 s51, s49, 0
    s_cmp_ge_u32 s51, 14
    s_cselect_b32 s50, 14, 0
    s_sub_u32 s51, s51, s50
    s_lshl_b32 s53, s51, 10
    s_add_u32 s53, s53, s40
    buffer_load_dwordx4 v[128:131], v16, s[8:11], s53 offen
    buffer_load_dwordx4 v[132:135], v17, s[8:11], s53 offen
    buffer_load_dwordx4 v[136:139], v18, s[8:11], s53 offen
    buffer_load_dwordx4 v[140:143], v19, s[8:11], s53 offen
    s_add_u32 s51, s49, 1
    s_cmp_ge_u32 s51, 14
    s_cselect_b32 s50, 14, 0
    s_sub_u32 s51, s51, s50
    s_lshl_b32 s52, s51, 15
    s_add_u32 s52, s52, s39
    s_add_u32 s42, s41, 4096
    s_mov_b32 m0, s42
    s_mov_b32 s43, s52
    buffer_load_dwordx4 v10, s[12:15], s43 offen lds
    s_add_u32 s42, s41, 5120
    s_mov_b32 m0, s42
    s_mov_b32 s43, s52
    buffer_load_dwordx4 v11, s[12:15], s43 offen lds
    s_add_u32 s42, s41, 6144
    s_mov_b32 m0, s42
    s_mov_b32 s43, s52
    buffer_load_dwordx4 v12, s[12:15], s43 offen lds
    s_add_u32 s42, s41, 7168
    s_mov_b32 m0, s42
    s_mov_b32 s43, s52
    buffer_load_dwordx4 v13, s[12:15], s43 offen lds
    s_add_u32 s51, s49, 1
    s_cmp_ge_u32 s51, 14
    s_cselect_b32 s50, 14, 0
    s_sub_u32 s51, s51, s50
    s_lshl_b32 s53, s51, 10
    s_add_u32 s53, s53, s40
    buffer_load_dwordx4 v[144:147], v16, s[8:11], s53 offen
    buffer_load_dwordx4 v[148:151], v17, s[8:11], s53 offen
    buffer_load_dwordx4 v[152:155], v18, s[8:11], s53 offen
    buffer_load_dwordx4 v[156:159], v19, s[8:11], s53 offen
    s_add_u32 s51, s49, 2
    s_cmp_ge_u32 s51, 14
    s_cselect_b32 s50, 14, 0
    s_sub_u32 s51, s51, s50
    s_lshl_b32 s52, s51, 15
    s_add_u32 s52, s52, s39
    s_add_u32 s42, s41, 8192
    s_mov_b32 m0, s42
    s_mov_b32 s43, s52
    buffer_load_dwordx4 v10, s[12:15], s43 offen lds
    s_add_u32 s42, s41, 9216
    s_mov_b32 m0, s42
    s_mov_b32 s43, s52
    buffer_load_dwordx4 v11, s[12:15], s43 offen lds
    s_add_u32 s42, s41, 10240
    s_mov_b32 m0, s42
    s_mov_b32 s43, s52
    buffer_load_dwordx4 v12, s[12:15], s43 offen lds
    s_add_u32 s42, s41, 11264
    s_mov_b32 m0, s42
    s_mov_b32 s43, s52
    buffer_load_dwordx4 v13, s[12:15], s43 offen lds
    s_add_u32 s51, s49, 2
    s_cmp_ge_u32 s51, 14
    s_cselect_b32 s50, 14, 0
    s_sub_u32 s51, s51, s50
    s_lshl_b32 s53, s51, 10
    s_add_u32 s53, s53, s40
    buffer_load_dwordx4 v[160:163], v16, s[8:11], s53 offen
    buffer_load_dwordx4 v[164:167], v17, s[8:11], s53 offen
    buffer_load_dwordx4 v[168:171], v18, s[8:11], s53 offen
    buffer_load_dwordx4 v[172:175], v19, s[8:11], s53 offen
    s_add_u32 s51, s49, 3
    s_cmp_ge_u32 s51, 14
    s_cselect_b32 s50, 14, 0
    s_sub_u32 s51, s51, s50
    s_lshl_b32 s52, s51, 15
    s_add_u32 s52, s52, s39
    s_add_u32 s42, s41, 12288
    s_mov_b32 m0, s42
    s_mov_b32 s43, s52
    buffer_load_dwordx4 v10, s[12:15], s43 offen lds
    s_add_u32 s42, s41, 13312
    s_mov_b32 m0, s42
    s_mov_b32 s43, s52
    buffer_load_dwordx4 v11, s[12:15], s43 offen lds
    s_add_u32 s42, s41, 14336
    s_mov_b32 m0, s42
    s_mov_b32 s43, s52
    buffer_load_dwordx4 v12, s[12:15], s43 offen lds
    s_add_u32 s42, s41, 15360
    s_mov_b32 m0, s42
    s_mov_b32 s43, s52
    buffer_load_dwordx4 v13, s[12:15], s43 offen lds
    s_add_u32 s51, s49, 3
    s_cmp_ge_u32 s51, 14
    s_cselect_b32 s50, 14, 0
    s_sub_u32 s51, s51, s50
    s_lshl_b32 s53, s51, 10
    s_add_u32 s53, s53, s40
    buffer_load_dwordx4 v[176:179], v16, s[8:11], s53 offen
    buffer_load_dwordx4 v[180:183], v17, s[8:11], s53 offen
    buffer_load_dwordx4 v[184:187], v18, s[8:11], s53 offen
    buffer_load_dwordx4 v[188:191], v19, s[8:11], s53 offen
    s_add_u32 s51, s49, 4
    s_cmp_ge_u32 s51, 14
    s_cselect_b32 s50, 14, 0
    s_sub_u32 s51, s51, s50
    s_lshl_b32 s53, s51, 10
    s_add_u32 s53, s53, s40
    buffer_load_dwordx4 v[192:195], v16, s[8:11], s53 offen
    buffer_load_dwordx4 v[196:199], v17, s[8:11], s53 offen
    buffer_load_dwordx4 v[200:203], v18, s[8:11], s53 offen
    buffer_load_dwordx4 v[204:207], v19, s[8:11], s53 offen
    s_add_u32 s51, s49, 5
    s_cmp_ge_u32 s51, 14
    s_cselect_b32 s50, 14, 0
    s_sub_u32 s51, s51, s50
    s_lshl_b32 s53, s51, 10
    s_add_u32 s53, s53, s40
    buffer_load_dwordx4 v[208:211], v16, s[8:11], s53 offen
    buffer_load_dwordx4 v[212:215], v17, s[8:11], s53 offen
    buffer_load_dwordx4 v[216:219], v18, s[8:11], s53 offen
    buffer_load_dwordx4 v[220:223], v19, s[8:11], s53 offen
    buffer_load_dwordx4 v[24:27], v6, s[44:47], s35 offen
    buffer_load_dwordx4 v[28:31], v6, s[44:47], s35 offen offset:16
    v_lshrrev_b32 v14, 2, v3
    v_and_b32 v15, 1, v4
    v_lshl_add_u32 v14, v15, 2, v14
    v_lshrrev_b32 v15, 1, v4
    v_lshl_add_u32 v15, v15, 4, v14
    v_lshrrev_b32 v14, 1, v15
    v_and_b32 v14, 3, v14
    v_lshlrev_b32 v15, 7, v15
    v_and_b32 v9, 3, v1
    v_lshl_add_u32 v15, v9, 3, v15
    v_add_u32 v15, s41, v15
    v_xor_b32 v9, 0, v14
    v_lshl_add_u32 v20, v9, 5, v15
    v_xor_b32 v9, 1, v14
    v_lshl_add_u32 v21, v9, 5, v15
    v_xor_b32 v9, 2, v14
    v_lshl_add_u32 v22, v9, 5, v15
    v_xor_b32 v9, 3, v14
    v_lshl_add_u32 v23, v9, 5, v15
    s_waitcnt vmcnt(38)
    ds_read_b64_tr_b16 v[32:33], v20 offset:0
    ds_read_b64_tr_b16 v[34:35], v20 offset:1024
    ds_read_b64_tr_b16 v[36:37], v21 offset:0
    ds_read_b64_tr_b16 v[38:39], v21 offset:1024
    ds_read_b64_tr_b16 v[40:41], v22 offset:0
    ds_read_b64_tr_b16 v[42:43], v22 offset:1024
    ds_read_b64_tr_b16 v[44:45], v23 offset:0
    ds_read_b64_tr_b16 v[46:47], v23 offset:1024
    s_waitcnt vmcnt(30) lgkmcnt(0)
    v_mfma_f32_16x16x32_bf16 v[64:67], v[32:35], v[128:131], 0
    ds_read_b64_tr_b16 v[48:49], v20 offset:4096
    v_mfma_f32_16x16x32_bf16 v[80:83], v[32:35], v[132:135], 0
    ds_read_b64_tr_b16 v[50:51], v20 offset:5120
    v_mfma_f32_16x16x32_bf16 v[96:99], v[32:35], v[136:139], 0
    ds_read_b64_tr_b16 v[52:53], v21 offset:4096
    v_mfma_f32_16x16x32_bf16 v[112:115], v[32:35], v[140:143], 0
    ds_read_b64_tr_b16 v[54:55], v21 offset:5120
    v_mfma_f32_16x16x32_bf16 v[68:71], v[36:39], v[128:131], 0
    ds_read_b64_tr_b16 v[56:57], v22 offset:4096
    v_mfma_f32_16x16x32_bf16 v[84:87], v[36:39], v[132:135], 0
    ds_read_b64_tr_b16 v[58:59], v22 offset:5120
    v_mfma_f32_16x16x32_bf16 v[100:103], v[36:39], v[136:139], 0
    ds_read_b64_tr_b16 v[60:61], v23 offset:4096
    v_mfma_f32_16x16x32_bf16 v[116:119], v[36:39], v[140:143], 0
    ds_read_b64_tr_b16 v[62:63], v23 offset:5120
    v_mfma_f32_16x16x32_bf16 v[72:75], v[40:43], v[128:131], 0
    s_add_u32 s51, s49, 4
    s_cmp_ge_u32 s51, 14
    s_cselect_b32 s50, 14, 0
    s_sub_u32 s51, s51, s50
    s_lshl_b32 s52, s51, 15
    s_add_u32 s52, s52, s39
    s_add_u32 s42, s41, 16384
    s_mov_b32 m0, s42
    s_mov_b32 s43, s52
    buffer_load_dwordx4 v10, s[12:15], s43 offen lds
    v_mfma_f32_16x16x32_bf16 v[88:91], v[40:43], v[132:135], 0
    s_add_u32 s42, s41, 17408
    s_mov_b32 m0, s42
    s_mov_b32 s43, s52
    buffer_load_dwordx4 v11, s[12:15], s43 offen lds
    v_mfma_f32_16x16x32_bf16 v[104:107], v[40:43], v[136:139], 0
    s_add_u32 s42, s41, 18432
    s_mov_b32 m0, s42
    s_mov_b32 s43, s52
    buffer_load_dwordx4 v12, s[12:15], s43 offen lds
    v_mfma_f32_16x16x32_bf16 v[120:123], v[40:43], v[140:143], 0
    s_add_u32 s42, s41, 19456
    s_mov_b32 m0, s42
    s_mov_b32 s43, s52
    buffer_load_dwordx4 v13, s[12:15], s43 offen lds
    v_mfma_f32_16x16x32_bf16 v[76:79], v[44:47], v[128:131], 0
    s_add_u32 s51, s49, 6
    s_cmp_ge_u32 s51, 14
    s_cselect_b32 s50, 14, 0
    s_sub_u32 s51, s51, s50
    s_lshl_b32 s53, s51, 10
    s_add_u32 s53, s53, s40
    buffer_load_dwordx4 a[0:3], v16, s[8:11], s53 offen
    v_mfma_f32_16x16x32_bf16 v[92:95], v[44:47], v[132:135], 0
    buffer_load_dwordx4 a[4:7], v17, s[8:11], s53 offen
    v_mfma_f32_16x16x32_bf16 v[108:111], v[44:47], v[136:139], 0
    buffer_load_dwordx4 a[8:11], v18, s[8:11], s53 offen
    v_mfma_f32_16x16x32_bf16 v[124:127], v[44:47], v[140:143], 0
    buffer_load_dwordx4 a[12:15], v19, s[8:11], s53 offen
    s_waitcnt vmcnt(30) lgkmcnt(0)
    v_mfma_f32_16x16x32_bf16 v[64:67], v[48:51], v[144:147], v[64:67]
    ds_read_b64_tr_b16 v[32:33], v20 offset:8192
    v_mfma_f32_16x16x32_bf16 v[80:83], v[48:51], v[148:151], v[80:83]
    ds_read_b64_tr_b16 v[34:35], v20 offset:9216
    v_mfma_f32_16x16x32_bf16 v[96:99], v[48:51], v[152:155], v[96:99]
    ds_read_b64_tr_b16 v[36:37], v21 offset:8192
    v_mfma_f32_16x16x32_bf16 v[112:115], v[48:51], v[156:159], v[112:115]
    ds_read_b64_tr_b16 v[38:39], v21 offset:9216
    v_mfma_f32_16x16x32_bf16 v[68:71], v[52:55], v[144:147], v[68:71]
    ds_read_b64_tr_b16 v[40:41], v22 offset:8192
    v_mfma_f32_16x16x32_bf16 v[84:87], v[52:55], v[148:151], v[84:87]
    ds_read_b64_tr_b16 v[42:43], v22 offset:9216
    v_mfma_f32_16x16x32_bf16 v[100:103], v[52:55], v[152:155], v[100:103]
    ds_read_b64_tr_b16 v[44:45], v23 offset:8192
    v_mfma_f32_16x16x32_bf16 v[116:119], v[52:55], v[156:159], v[116:119]
    ds_read_b64_tr_b16 v[46:47], v23 offset:9216
    v_mfma_f32_16x16x32_bf16 v[72:75], v[56:59], v[144:147], v[72:75]
    s_add_u32 s51, s49, 5
    s_cmp_ge_u32 s51, 14
    s_cselect_b32 s50, 14, 0
    s_sub_u32 s51, s51, s50
    s_lshl_b32 s52, s51, 15
    s_add_u32 s52, s52, s39
    s_add_u32 s42, s41, 0
    s_mov_b32 m0, s42
    s_mov_b32 s43, s52
    buffer_load_dwordx4 v10, s[12:15], s43 offen lds
    v_mfma_f32_16x16x32_bf16 v[88:91], v[56:59], v[148:151], v[88:91]
    s_add_u32 s42, s41, 1024
    s_mov_b32 m0, s42
    s_mov_b32 s43, s52
    buffer_load_dwordx4 v11, s[12:15], s43 offen lds
    v_mfma_f32_16x16x32_bf16 v[104:107], v[56:59], v[152:155], v[104:107]
    s_add_u32 s42, s41, 2048
    s_mov_b32 m0, s42
    s_mov_b32 s43, s52
    buffer_load_dwordx4 v12, s[12:15], s43 offen lds
    v_mfma_f32_16x16x32_bf16 v[120:123], v[56:59], v[156:159], v[120:123]
    s_add_u32 s42, s41, 3072
    s_mov_b32 m0, s42
    s_mov_b32 s43, s52
    buffer_load_dwordx4 v13, s[12:15], s43 offen lds
    v_mfma_f32_16x16x32_bf16 v[76:79], v[60:63], v[144:147], v[76:79]
    s_add_u32 s51, s49, 7
    s_cmp_ge_u32 s51, 14
    s_cselect_b32 s50, 14, 0
    s_sub_u32 s51, s51, s50
    s_lshl_b32 s53, s51, 10
    s_add_u32 s53, s53, s40
    buffer_load_dwordx4 v[128:131], v16, s[8:11], s53 offen
    v_mfma_f32_16x16x32_bf16 v[92:95], v[60:63], v[148:151], v[92:95]
    buffer_load_dwordx4 v[132:135], v17, s[8:11], s53 offen
    v_mfma_f32_16x16x32_bf16 v[108:111], v[60:63], v[152:155], v[108:111]
    buffer_load_dwordx4 v[136:139], v18, s[8:11], s53 offen
    v_mfma_f32_16x16x32_bf16 v[124:127], v[60:63], v[156:159], v[124:127]
    buffer_load_dwordx4 v[140:143], v19, s[8:11], s53 offen
    s_waitcnt vmcnt(30) lgkmcnt(0)
    v_mfma_f32_16x16x32_bf16 v[64:67], v[32:35], v[160:163], v[64:67]
    ds_read_b64_tr_b16 v[48:49], v20 offset:12288
    v_mfma_f32_16x16x32_bf16 v[80:83], v[32:35], v[164:167], v[80:83]
    ds_read_b64_tr_b16 v[50:51], v20 offset:13312
    v_mfma_f32_16x16x32_bf16 v[96:99], v[32:35], v[168:171], v[96:99]
    ds_read_b64_tr_b16 v[52:53], v21 offset:12288
    v_mfma_f32_16x16x32_bf16 v[112:115], v[32:35], v[172:175], v[112:115]
    ds_read_b64_tr_b16 v[54:55], v21 offset:13312
    v_mfma_f32_16x16x32_bf16 v[68:71], v[36:39], v[160:163], v[68:71]
    ds_read_b64_tr_b16 v[56:57], v22 offset:12288
    v_mfma_f32_16x16x32_bf16 v[84:87], v[36:39], v[164:167], v[84:87]
    ds_read_b64_tr_b16 v[58:59], v22 offset:13312
    v_mfma_f32_16x16x32_bf16 v[100:103], v[36:39], v[168:171], v[100:103]
    ds_read_b64_tr_b16 v[60:61], v23 offset:12288
    v_mfma_f32_16x16x32_bf16 v[116:119], v[36:39], v[172:175], v[116:119]
    ds_read_b64_tr_b16 v[62:63], v23 offset:13312
    v_mfma_f32_16x16x32_bf16 v[72:75], v[40:43], v[160:163], v[72:75]
    s_add_u32 s51, s49, 6
    s_cmp_ge_u32 s51, 14
    s_cselect_b32 s50, 14, 0
    s_sub_u32 s51, s51, s50
    s_lshl_b32 s52, s51, 15
    s_add_u32 s52, s52, s39
    s_add_u32 s42, s41, 4096
    s_mov_b32 m0, s42
    s_mov_b32 s43, s52
    buffer_load_dwordx4 v10, s[12:15], s43 offen lds
    v_mfma_f32_16x16x32_bf16 v[88:91], v[40:43], v[164:167], v[88:91]
    s_add_u32 s42, s41, 5120
    s_mov_b32 m0, s42
    s_mov_b32 s43, s52
    buffer_load_dwordx4 v11, s[12:15], s43 offen lds
    v_mfma_f32_16x16x32_bf16 v[104:107], v[40:43], v[168:171], v[104:107]
    s_add_u32 s42, s41, 6144
    s_mov_b32 m0, s42
    s_mov_b32 s43, s52
    buffer_load_dwordx4 v12, s[12:15], s43 offen lds
    v_mfma_f32_16x16x32_bf16 v[120:123], v[40:43], v[172:175], v[120:123]
    s_add_u32 s42, s41, 7168
    s_mov_b32 m0, s42
    s_mov_b32 s43, s52
    buffer_load_dwordx4 v13, s[12:15], s43 offen lds
    v_mfma_f32_16x16x32_bf16 v[76:79], v[44:47], v[160:163], v[76:79]
    s_add_u32 s51, s49, 8
    s_cmp_ge_u32 s51, 14
    s_cselect_b32 s50, 14, 0
    s_sub_u32 s51, s51, s50
    s_lshl_b32 s53, s51, 10
    s_add_u32 s53, s53, s40
    buffer_load_dwordx4 v[144:147], v16, s[8:11], s53 offen
    v_mfma_f32_16x16x32_bf16 v[92:95], v[44:47], v[164:167], v[92:95]
    buffer_load_dwordx4 v[148:151], v17, s[8:11], s53 offen
    v_mfma_f32_16x16x32_bf16 v[108:111], v[44:47], v[168:171], v[108:111]
    buffer_load_dwordx4 v[152:155], v18, s[8:11], s53 offen
    v_mfma_f32_16x16x32_bf16 v[124:127], v[44:47], v[172:175], v[124:127]
    buffer_load_dwordx4 v[156:159], v19, s[8:11], s53 offen
    s_waitcnt vmcnt(20) lgkmcnt(0)
    v_mfma_f32_16x16x32_bf16 v[64:67], v[48:51], v[176:179], v[64:67]
    ds_read_b64_tr_b16 v[32:33], v20 offset:16384
    v_mfma_f32_16x16x32_bf16 v[80:83], v[48:51], v[180:183], v[80:83]
    ds_read_b64_tr_b16 v[34:35], v20 offset:17408
    v_mfma_f32_16x16x32_bf16 v[96:99], v[48:51], v[184:187], v[96:99]
    ds_read_b64_tr_b16 v[36:37], v21 offset:16384
    v_mfma_f32_16x16x32_bf16 v[112:115], v[48:51], v[188:191], v[112:115]
    ds_read_b64_tr_b16 v[38:39], v21 offset:17408
    v_mfma_f32_16x16x32_bf16 v[68:71], v[52:55], v[176:179], v[68:71]
    ds_read_b64_tr_b16 v[40:41], v22 offset:16384
    v_mfma_f32_16x16x32_bf16 v[84:87], v[52:55], v[180:183], v[84:87]
    ds_read_b64_tr_b16 v[42:43], v22 offset:17408
    v_mfma_f32_16x16x32_bf16 v[100:103], v[52:55], v[184:187], v[100:103]
    ds_read_b64_tr_b16 v[44:45], v23 offset:16384
    v_mfma_f32_16x16x32_bf16 v[116:119], v[52:55], v[188:191], v[116:119]
    ds_read_b64_tr_b16 v[46:47], v23 offset:17408
    v_mfma_f32_16x16x32_bf16 v[72:75], v[56:59], v[176:179], v[72:75]
    s_add_u32 s51, s49, 7
    s_cmp_ge_u32 s51, 14
    s_cselect_b32 s50, 14, 0
    s_sub_u32 s51, s51, s50
    s_lshl_b32 s52, s51, 15
    s_add_u32 s52, s52, s39
    s_add_u32 s42, s41, 8192
    s_mov_b32 m0, s42
    s_mov_b32 s43, s52
    buffer_load_dwordx4 v10, s[12:15], s43 offen lds
    v_mfma_f32_16x16x32_bf16 v[88:91], v[56:59], v[180:183], v[88:91]
    s_add_u32 s42, s41, 9216
    s_mov_b32 m0, s42
    s_mov_b32 s43, s52
    buffer_load_dwordx4 v11, s[12:15], s43 offen lds
    v_mfma_f32_16x16x32_bf16 v[104:107], v[56:59], v[184:187], v[104:107]
    s_add_u32 s42, s41, 10240
    s_mov_b32 m0, s42
    s_mov_b32 s43, s52
    buffer_load_dwordx4 v12, s[12:15], s43 offen lds
    v_mfma_f32_16x16x32_bf16 v[120:123], v[56:59], v[188:191], v[120:123]
    s_add_u32 s42, s41, 11264
    s_mov_b32 m0, s42
    s_mov_b32 s43, s52
    buffer_load_dwordx4 v13, s[12:15], s43 offen lds
    v_mfma_f32_16x16x32_bf16 v[76:79], v[60:63], v[176:179], v[76:79]
    s_add_u32 s51, s49, 9
    s_cmp_ge_u32 s51, 14
    s_cselect_b32 s50, 14, 0
    s_sub_u32 s51, s51, s50
    s_lshl_b32 s53, s51, 10
    s_add_u32 s53, s53, s40
    buffer_load_dwordx4 v[160:163], v16, s[8:11], s53 offen
    v_mfma_f32_16x16x32_bf16 v[92:95], v[60:63], v[180:183], v[92:95]
    buffer_load_dwordx4 v[164:167], v17, s[8:11], s53 offen
    v_mfma_f32_16x16x32_bf16 v[108:111], v[60:63], v[184:187], v[108:111]
    buffer_load_dwordx4 v[168:171], v18, s[8:11], s53 offen
    v_mfma_f32_16x16x32_bf16 v[124:127], v[60:63], v[188:191], v[124:127]
    buffer_load_dwordx4 v[172:175], v19, s[8:11], s53 offen
    s_waitcnt vmcnt(20) lgkmcnt(0)
    v_mfma_f32_16x16x32_bf16 v[64:67], v[32:35], v[192:195], v[64:67]
    ds_read_b64_tr_b16 v[48:49], v20 offset:0
    v_mfma_f32_16x16x32_bf16 v[80:83], v[32:35], v[196:199], v[80:83]
    ds_read_b64_tr_b16 v[50:51], v20 offset:1024
    v_mfma_f32_16x16x32_bf16 v[96:99], v[32:35], v[200:203], v[96:99]
    ds_read_b64_tr_b16 v[52:53], v21 offset:0
    v_mfma_f32_16x16x32_bf16 v[112:115], v[32:35], v[204:207], v[112:115]
    ds_read_b64_tr_b16 v[54:55], v21 offset:1024
    v_mfma_f32_16x16x32_bf16 v[68:71], v[36:39], v[192:195], v[68:71]
    ds_read_b64_tr_b16 v[56:57], v22 offset:0
    v_mfma_f32_16x16x32_bf16 v[84:87], v[36:39], v[196:199], v[84:87]
    ds_read_b64_tr_b16 v[58:59], v22 offset:1024
    v_mfma_f32_16x16x32_bf16 v[100:103], v[36:39], v[200:203], v[100:103]
    ds_read_b64_tr_b16 v[60:61], v23 offset:0
    v_mfma_f32_16x16x32_bf16 v[116:119], v[36:39], v[204:207], v[116:119]
    ds_read_b64_tr_b16 v[62:63], v23 offset:1024
    v_mfma_f32_16x16x32_bf16 v[72:75], v[40:43], v[192:195], v[72:75]
    s_add_u32 s51, s49, 8
    s_cmp_ge_u32 s51, 14
    s_cselect_b32 s50, 14, 0
    s_sub_u32 s51, s51, s50
    s_lshl_b32 s52, s51, 15
    s_add_u32 s52, s52, s39
    s_add_u32 s42, s41, 12288
    s_mov_b32 m0, s42
    s_mov_b32 s43, s52
    buffer_load_dwordx4 v10, s[12:15], s43 offen lds
    v_mfma_f32_16x16x32_bf16 v[88:91], v[40:43], v[196:199], v[88:91]
    s_add_u32 s42, s41, 13312
    s_mov_b32 m0, s42
    s_mov_b32 s43, s52
    buffer_load_dwordx4 v11, s[12:15], s43 offen lds
    v_mfma_f32_16x16x32_bf16 v[104:107], v[40:43], v[200:203], v[104:107]
    s_add_u32 s42, s41, 14336
    s_mov_b32 m0, s42
    s_mov_b32 s43, s52
    buffer_load_dwordx4 v12, s[12:15], s43 offen lds
    v_mfma_f32_16x16x32_bf16 v[120:123], v[40:43], v[204:207], v[120:123]
    s_add_u32 s42, s41, 15360
    s_mov_b32 m0, s42
    s_mov_b32 s43, s52
    buffer_load_dwordx4 v13, s[12:15], s43 offen lds
    v_mfma_f32_16x16x32_bf16 v[76:79], v[44:47], v[192:195], v[76:79]
    s_add_u32 s51, s49, 10
    s_cmp_ge_u32 s51, 14
    s_cselect_b32 s50, 14, 0
    s_sub_u32 s51, s51, s50
    s_lshl_b32 s53, s51, 10
    s_add_u32 s53, s53, s40
    buffer_load_dwordx4 v[176:179], v16, s[8:11], s53 offen
    v_mfma_f32_16x16x32_bf16 v[92:95], v[44:47], v[196:199], v[92:95]
    buffer_load_dwordx4 v[180:183], v17, s[8:11], s53 offen
    v_mfma_f32_16x16x32_bf16 v[108:111], v[44:47], v[200:203], v[108:111]
    buffer_load_dwordx4 v[184:187], v18, s[8:11], s53 offen
    v_mfma_f32_16x16x32_bf16 v[124:127], v[44:47], v[204:207], v[124:127]
    buffer_load_dwordx4 v[188:191], v19, s[8:11], s53 offen
    s_waitcnt vmcnt(20) lgkmcnt(0)
    v_mfma_f32_16x16x32_bf16 v[64:67], v[48:51], v[208:211], v[64:67]
    ds_read_b64_tr_b16 v[32:33], v20 offset:4096
    v_mfma_f32_16x16x32_bf16 v[80:83], v[48:51], v[212:215], v[80:83]
    ds_read_b64_tr_b16 v[34:35], v20 offset:5120
    v_mfma_f32_16x16x32_bf16 v[96:99], v[48:51], v[216:219], v[96:99]
    ds_read_b64_tr_b16 v[36:37], v21 offset:4096
    v_mfma_f32_16x16x32_bf16 v[112:115], v[48:51], v[220:223], v[112:115]
    ds_read_b64_tr_b16 v[38:39], v21 offset:5120
    v_mfma_f32_16x16x32_bf16 v[68:71], v[52:55], v[208:211], v[68:71]
    ds_read_b64_tr_b16 v[40:41], v22 offset:4096
    v_mfma_f32_16x16x32_bf16 v[84:87], v[52:55], v[212:215], v[84:87]
    ds_read_b64_tr_b16 v[42:43], v22 offset:5120
    v_mfma_f32_16x16x32_bf16 v[100:103], v[52:55], v[216:219], v[100:103]
    ds_read_b64_tr_b16 v[44:45], v23 offset:4096
    v_mfma_f32_16x16x32_bf16 v[116:119], v[52:55], v[220:223], v[116:119]
    ds_read_b64_tr_b16 v[46:47], v23 offset:5120
    v_mfma_f32_16x16x32_bf16 v[72:75], v[56:59], v[208:211], v[72:75]
    s_add_u32 s51, s49, 9
    s_cmp_ge_u32 s51, 14
    s_cselect_b32 s50, 14, 0
    s_sub_u32 s51, s51, s50
    s_lshl_b32 s52, s51, 15
    s_add_u32 s52, s52, s39
    s_add_u32 s42, s41, 16384
    s_mov_b32 m0, s42
    s_mov_b32 s43, s52
    buffer_load_dwordx4 v10, s[12:15], s43 offen lds
    v_mfma_f32_16x16x32_bf16 v[88:91], v[56:59], v[212:215], v[88:91]
    s_add_u32 s42, s41, 17408
    s_mov_b32 m0, s42
    s_mov_b32 s43, s52
    buffer_load_dwordx4 v11, s[12:15], s43 offen lds
    v_mfma_f32_16x16x32_bf16 v[104:107], v[56:59], v[216:219], v[104:107]
    s_add_u32 s42, s41, 18432
    s_mov_b32 m0, s42
    s_mov_b32 s43, s52
    buffer_load_dwordx4 v12, s[12:15], s43 offen lds
    v_mfma_f32_16x16x32_bf16 v[120:123], v[56:59], v[220:223], v[120:123]
    s_add_u32 s42, s41, 19456
    s_mov_b32 m0, s42
    s_mov_b32 s43, s52
    buffer_load_dwordx4 v13, s[12:15], s43 offen lds
    v_mfma_f32_16x16x32_bf16 v[76:79], v[60:63], v[208:211], v[76:79]
    s_add_u32 s51, s49, 11
    s_cmp_ge_u32 s51, 14
    s_cselect_b32 s50, 14, 0
    s_sub_u32 s51, s51, s50
    s_lshl_b32 s53, s51, 10
    s_add_u32 s53, s53, s40
    buffer_load_dwordx4 v[192:195], v16, s[8:11], s53 offen
    v_mfma_f32_16x16x32_bf16 v[92:95], v[60:63], v[212:215], v[92:95]
    buffer_load_dwordx4 v[196:199], v17, s[8:11], s53 offen
    v_mfma_f32_16x16x32_bf16 v[108:111], v[60:63], v[216:219], v[108:111]
    buffer_load_dwordx4 v[200:203], v18, s[8:11], s53 offen
    v_mfma_f32_16x16x32_bf16 v[124:127], v[60:63], v[220:223], v[124:127]
    buffer_load_dwordx4 v[204:207], v19, s[8:11], s53 offen
    s_waitcnt vmcnt(20) lgkmcnt(0)
    v_mfma_f32_16x16x32_bf16 v[64:67], v[32:35], a[0:3], v[64:67]
    ds_read_b64_tr_b16 v[48:49], v20 offset:8192
    v_mfma_f32_16x16x32_bf16 v[80:83], v[32:35], a[4:7], v[80:83]
    ds_read_b64_tr_b16 v[50:51], v20 offset:9216
    v_mfma_f32_16x16x32_bf16 v[96:99], v[32:35], a[8:11], v[96:99]
    ds_read_b64_tr_b16 v[52:53], v21 offset:8192
    v_mfma_f32_16x16x32_bf16 v[112:115], v[32:35], a[12:15], v[112:115]
    ds_read_b64_tr_b16 v[54:55], v21 offset:9216
    v_mfma_f32_16x16x32_bf16 v[68:71], v[36:39], a[0:3], v[68:71]
    ds_read_b64_tr_b16 v[56:57], v22 offset:8192
    v_mfma_f32_16x16x32_bf16 v[84:87], v[36:39], a[4:7], v[84:87]
    ds_read_b64_tr_b16 v[58:59], v22 offset:9216
    v_mfma_f32_16x16x32_bf16 v[100:103], v[36:39], a[8:11], v[100:103]
    ds_read_b64_tr_b16 v[60:61], v23 offset:8192
    v_mfma_f32_16x16x32_bf16 v[116:119], v[36:39], a[12:15], v[116:119]
    ds_read_b64_tr_b16 v[62:63], v23 offset:9216
    v_mfma_f32_16x16x32_bf16 v[72:75], v[40:43], a[0:3], v[72:75]
    s_add_u32 s51, s49, 10
    s_cmp_ge_u32 s51, 14
    s_cselect_b32 s50, 14, 0
    s_sub_u32 s51, s51, s50
    s_lshl_b32 s52, s51, 15
    s_add_u32 s52, s52, s39
    s_add_u32 s42, s41, 0
    s_mov_b32 m0, s42
    s_mov_b32 s43, s52
    buffer_load_dwordx4 v10, s[12:15], s43 offen lds
    v_mfma_f32_16x16x32_bf16 v[88:91], v[40:43], a[4:7], v[88:91]
    s_add_u32 s42, s41, 1024
    s_mov_b32 m0, s42
    s_mov_b32 s43, s52
    buffer_load_dwordx4 v11, s[12:15], s43 offen lds
    v_mfma_f32_16x16x32_bf16 v[104:107], v[40:43], a[8:11], v[104:107]
    s_add_u32 s42, s41, 2048
    s_mov_b32 m0, s42
    s_mov_b32 s43, s52
    buffer_load_dwordx4 v12, s[12:15], s43 offen lds
    v_mfma_f32_16x16x32_bf16 v[120:123], v[40:43], a[12:15], v[120:123]
    s_add_u32 s42, s41, 3072
    s_mov_b32 m0, s42
    s_mov_b32 s43, s52
    buffer_load_dwordx4 v13, s[12:15], s43 offen lds
    v_mfma_f32_16x16x32_bf16 v[76:79], v[44:47], a[0:3], v[76:79]
    s_add_u32 s51, s49, 12
    s_cmp_ge_u32 s51, 14
    s_cselect_b32 s50, 14, 0
    s_sub_u32 s51, s51, s50
    s_lshl_b32 s53, s51, 10
    s_add_u32 s53, s53, s40
    buffer_load_dwordx4 v[208:211], v16, s[8:11], s53 offen
    v_mfma_f32_16x16x32_bf16 v[92:95], v[44:47], a[4:7], v[92:95]
    buffer_load_dwordx4 v[212:215], v17, s[8:11], s53 offen
    v_mfma_f32_16x16x32_bf16 v[108:111], v[44:47], a[8:11], v[108:111]
    buffer_load_dwordx4 v[216:219], v18, s[8:11], s53 offen
    v_mfma_f32_16x16x32_bf16 v[124:127], v[44:47], a[12:15], v[124:127]
    buffer_load_dwordx4 v[220:223], v19, s[8:11], s53 offen
    s_waitcnt vmcnt(20) lgkmcnt(0)
    v_mfma_f32_16x16x32_bf16 v[64:67], v[48:51], v[128:131], v[64:67]
    ds_read_b64_tr_b16 v[32:33], v20 offset:12288
    v_mfma_f32_16x16x32_bf16 v[80:83], v[48:51], v[132:135], v[80:83]
    ds_read_b64_tr_b16 v[34:35], v20 offset:13312
    v_mfma_f32_16x16x32_bf16 v[96:99], v[48:51], v[136:139], v[96:99]
    ds_read_b64_tr_b16 v[36:37], v21 offset:12288
    v_mfma_f32_16x16x32_bf16 v[112:115], v[48:51], v[140:143], v[112:115]
    ds_read_b64_tr_b16 v[38:39], v21 offset:13312
    v_mfma_f32_16x16x32_bf16 v[68:71], v[52:55], v[128:131], v[68:71]
    ds_read_b64_tr_b16 v[40:41], v22 offset:12288
    v_mfma_f32_16x16x32_bf16 v[84:87], v[52:55], v[132:135], v[84:87]
    ds_read_b64_tr_b16 v[42:43], v22 offset:13312
    v_mfma_f32_16x16x32_bf16 v[100:103], v[52:55], v[136:139], v[100:103]
    ds_read_b64_tr_b16 v[44:45], v23 offset:12288
    v_mfma_f32_16x16x32_bf16 v[116:119], v[52:55], v[140:143], v[116:119]
    ds_read_b64_tr_b16 v[46:47], v23 offset:13312
    v_mfma_f32_16x16x32_bf16 v[72:75], v[56:59], v[128:131], v[72:75]
    s_add_u32 s51, s49, 11
    s_cmp_ge_u32 s51, 14
    s_cselect_b32 s50, 14, 0
    s_sub_u32 s51, s51, s50
    s_lshl_b32 s52, s51, 15
    s_add_u32 s52, s52, s39
    s_add_u32 s42, s41, 4096
    s_mov_b32 m0, s42
    s_mov_b32 s43, s52
    buffer_load_dwordx4 v10, s[12:15], s43 offen lds
    v_mfma_f32_16x16x32_bf16 v[88:91], v[56:59], v[132:135], v[88:91]
    s_add_u32 s42, s41, 5120
    s_mov_b32 m0, s42
    s_mov_b32 s43, s52
    buffer_load_dwordx4 v11, s[12:15], s43 offen lds
    v_mfma_f32_16x16x32_bf16 v[104:107], v[56:59], v[136:139], v[104:107]
    s_add_u32 s42, s41, 6144
    s_mov_b32 m0, s42
    s_mov_b32 s43, s52
    buffer_load_dwordx4 v12, s[12:15], s43 offen lds
    v_mfma_f32_16x16x32_bf16 v[120:123], v[56:59], v[140:143], v[120:123]
    s_add_u32 s42, s41, 7168
    s_mov_b32 m0, s42
    s_mov_b32 s43, s52
    buffer_load_dwordx4 v13, s[12:15], s43 offen lds
    v_mfma_f32_16x16x32_bf16 v[76:79], v[60:63], v[128:131], v[76:79]
    s_add_u32 s51, s49, 13
    s_cmp_ge_u32 s51, 14
    s_cselect_b32 s50, 14, 0
    s_sub_u32 s51, s51, s50
    s_lshl_b32 s53, s51, 10
    s_add_u32 s53, s53, s40
    buffer_load_dwordx4 a[0:3], v16, s[8:11], s53 offen
    v_mfma_f32_16x16x32_bf16 v[92:95], v[60:63], v[132:135], v[92:95]
    buffer_load_dwordx4 a[4:7], v17, s[8:11], s53 offen
    v_mfma_f32_16x16x32_bf16 v[108:111], v[60:63], v[136:139], v[108:111]
    buffer_load_dwordx4 a[8:11], v18, s[8:11], s53 offen
    v_mfma_f32_16x16x32_bf16 v[124:127], v[60:63], v[140:143], v[124:127]
    buffer_load_dwordx4 a[12:15], v19, s[8:11], s53 offen
    s_waitcnt vmcnt(20) lgkmcnt(0)
    v_mfma_f32_16x16x32_bf16 v[64:67], v[32:35], v[144:147], v[64:67]
    ds_read_b64_tr_b16 v[48:49], v20 offset:16384
    v_mfma_f32_16x16x32_bf16 v[80:83], v[32:35], v[148:151], v[80:83]
    ds_read_b64_tr_b16 v[50:51], v20 offset:17408
    v_mfma_f32_16x16x32_bf16 v[96:99], v[32:35], v[152:155], v[96:99]
    ds_read_b64_tr_b16 v[52:53], v21 offset:16384
    v_mfma_f32_16x16x32_bf16 v[112:115], v[32:35], v[156:159], v[112:115]
    ds_read_b64_tr_b16 v[54:55], v21 offset:17408
    v_mfma_f32_16x16x32_bf16 v[68:71], v[36:39], v[144:147], v[68:71]
    ds_read_b64_tr_b16 v[56:57], v22 offset:16384
    v_mfma_f32_16x16x32_bf16 v[84:87], v[36:39], v[148:151], v[84:87]
    ds_read_b64_tr_b16 v[58:59], v22 offset:17408
    v_mfma_f32_16x16x32_bf16 v[100:103], v[36:39], v[152:155], v[100:103]
    ds_read_b64_tr_b16 v[60:61], v23 offset:16384
    v_mfma_f32_16x16x32_bf16 v[116:119], v[36:39], v[156:159], v[116:119]
    ds_read_b64_tr_b16 v[62:63], v23 offset:17408
    v_mfma_f32_16x16x32_bf16 v[72:75], v[40:43], v[144:147], v[72:75]
    s_add_u32 s51, s49, 12
    s_cmp_ge_u32 s51, 14
    s_cselect_b32 s50, 14, 0
    s_sub_u32 s51, s51, s50
    s_lshl_b32 s52, s51, 15
    s_add_u32 s52, s52, s39
    s_add_u32 s42, s41, 8192
    s_mov_b32 m0, s42
    s_mov_b32 s43, s52
    buffer_load_dwordx4 v10, s[12:15], s43 offen lds
    v_mfma_f32_16x16x32_bf16 v[88:91], v[40:43], v[148:151], v[88:91]
    s_add_u32 s42, s41, 9216
    s_mov_b32 m0, s42
    s_mov_b32 s43, s52
    buffer_load_dwordx4 v11, s[12:15], s43 offen lds
    v_mfma_f32_16x16x32_bf16 v[104:107], v[40:43], v[152:155], v[104:107]
    s_add_u32 s42, s41, 10240
    s_mov_b32 m0, s42
    s_mov_b32 s43, s52
    buffer_load_dwordx4 v12, s[12:15], s43 offen lds
    v_mfma_f32_16x16x32_bf16 v[120:123], v[40:43], v[156:159], v[120:123]
    s_add_u32 s42, s41, 11264
    s_mov_b32 m0, s42
    s_mov_b32 s43, s52
    buffer_load_dwordx4 v13, s[12:15], s43 offen lds
    v_mfma_f32_16x16x32_bf16 v[76:79], v[44:47], v[144:147], v[76:79]
    v_mfma_f32_16x16x32_bf16 v[92:95], v[44:47], v[148:151], v[92:95]
    v_mfma_f32_16x16x32_bf16 v[108:111], v[44:47], v[152:155], v[108:111]
    v_mfma_f32_16x16x32_bf16 v[124:127], v[44:47], v[156:159], v[124:127]
    s_waitcnt vmcnt(16) lgkmcnt(0)
    v_mfma_f32_16x16x32_bf16 v[64:67], v[48:51], v[160:163], v[64:67]
    ds_read_b64_tr_b16 v[32:33], v20 offset:0
    v_mfma_f32_16x16x32_bf16 v[80:83], v[48:51], v[164:167], v[80:83]
    ds_read_b64_tr_b16 v[34:35], v20 offset:1024
    v_mfma_f32_16x16x32_bf16 v[96:99], v[48:51], v[168:171], v[96:99]
    ds_read_b64_tr_b16 v[36:37], v21 offset:0
    v_mfma_f32_16x16x32_bf16 v[112:115], v[48:51], v[172:175], v[112:115]
    ds_read_b64_tr_b16 v[38:39], v21 offset:1024
    v_mfma_f32_16x16x32_bf16 v[68:71], v[52:55], v[160:163], v[68:71]
    ds_read_b64_tr_b16 v[40:41], v22 offset:0
    v_mfma_f32_16x16x32_bf16 v[84:87], v[52:55], v[164:167], v[84:87]
    ds_read_b64_tr_b16 v[42:43], v22 offset:1024
    v_mfma_f32_16x16x32_bf16 v[100:103], v[52:55], v[168:171], v[100:103]
    ds_read_b64_tr_b16 v[44:45], v23 offset:0
    v_mfma_f32_16x16x32_bf16 v[116:119], v[52:55], v[172:175], v[116:119]
    ds_read_b64_tr_b16 v[46:47], v23 offset:1024
    v_mfma_f32_16x16x32_bf16 v[72:75], v[56:59], v[160:163], v[72:75]
    s_add_u32 s51, s49, 13
    s_cmp_ge_u32 s51, 14
    s_cselect_b32 s50, 14, 0
    s_sub_u32 s51, s51, s50
    s_lshl_b32 s52, s51, 15
    s_add_u32 s52, s52, s39
    s_add_u32 s42, s41, 12288
    s_mov_b32 m0, s42
    s_mov_b32 s43, s52
    buffer_load_dwordx4 v10, s[12:15], s43 offen lds
    v_mfma_f32_16x16x32_bf16 v[88:91], v[56:59], v[164:167], v[88:91]
    s_add_u32 s42, s41, 13312
    s_mov_b32 m0, s42
    s_mov_b32 s43, s52
    buffer_load_dwordx4 v11, s[12:15], s43 offen lds
    v_mfma_f32_16x16x32_bf16 v[104:107], v[56:59], v[168:171], v[104:107]
    s_add_u32 s42, s41, 14336
    s_mov_b32 m0, s42
    s_mov_b32 s43, s52
    buffer_load_dwordx4 v12, s[12:15], s43 offen lds
    v_mfma_f32_16x16x32_bf16 v[120:123], v[56:59], v[172:175], v[120:123]
    s_add_u32 s42, s41, 15360
    s_mov_b32 m0, s42
    s_mov_b32 s43, s52
    buffer_load_dwordx4 v13, s[12:15], s43 offen lds
    v_mfma_f32_16x16x32_bf16 v[76:79], v[60:63], v[160:163], v[76:79]
    v_mfma_f32_16x16x32_bf16 v[92:95], v[60:63], v[164:167], v[92:95]
    v_mfma_f32_16x16x32_bf16 v[108:111], v[60:63], v[168:171], v[108:111]
    v_mfma_f32_16x16x32_bf16 v[124:127], v[60:63], v[172:175], v[124:127]
    s_waitcnt vmcnt(12) lgkmcnt(0)
    v_mfma_f32_16x16x32_bf16 v[64:67], v[32:35], v[176:179], v[64:67]
    ds_read_b64_tr_b16 v[48:49], v20 offset:4096
    v_mfma_f32_16x16x32_bf16 v[80:83], v[32:35], v[180:183], v[80:83]
    ds_read_b64_tr_b16 v[50:51], v20 offset:5120
    v_mfma_f32_16x16x32_bf16 v[96:99], v[32:35], v[184:187], v[96:99]
    ds_read_b64_tr_b16 v[52:53], v21 offset:4096
    v_mfma_f32_16x16x32_bf16 v[112:115], v[32:35], v[188:191], v[112:115]
    ds_read_b64_tr_b16 v[54:55], v21 offset:5120
    v_mfma_f32_16x16x32_bf16 v[68:71], v[36:39], v[176:179], v[68:71]
    ds_read_b64_tr_b16 v[56:57], v22 offset:4096
    v_mfma_f32_16x16x32_bf16 v[84:87], v[36:39], v[180:183], v[84:87]
    ds_read_b64_tr_b16 v[58:59], v22 offset:5120
    v_mfma_f32_16x16x32_bf16 v[100:103], v[36:39], v[184:187], v[100:103]
    ds_read_b64_tr_b16 v[60:61], v23 offset:4096
    v_mfma_f32_16x16x32_bf16 v[116:119], v[36:39], v[188:191], v[116:119]
    ds_read_b64_tr_b16 v[62:63], v23 offset:5120
    v_mfma_f32_16x16x32_bf16 v[72:75], v[40:43], v[176:179], v[72:75]
    v_mfma_f32_16x16x32_bf16 v[88:91], v[40:43], v[180:183], v[88:91]
    v_mfma_f32_16x16x32_bf16 v[104:107], v[40:43], v[184:187], v[104:107]
    v_mfma_f32_16x16x32_bf16 v[120:123], v[40:43], v[188:191], v[120:123]
    v_mfma_f32_16x16x32_bf16 v[76:79], v[44:47], v[176:179], v[76:79]
    v_mfma_f32_16x16x32_bf16 v[92:95], v[44:47], v[180:183], v[92:95]
    v_mfma_f32_16x16x32_bf16 v[108:111], v[44:47], v[184:187], v[108:111]
    v_mfma_f32_16x16x32_bf16 v[124:127], v[44:47], v[188:191], v[124:127]
    s_waitcnt vmcnt(4) lgkmcnt(0)
    v_mfma_f32_16x16x32_bf16 v[64:67], v[48:51], v[192:195], v[64:67]
    ds_read_b64_tr_b16 v[32:33], v20 offset:8192
    v_mfma_f32_16x16x32_bf16 v[80:83], v[48:51], v[196:199], v[80:83]
    ds_read_b64_tr_b16 v[34:35], v20 offset:9216
    v_mfma_f32_16x16x32_bf16 v[96:99], v[48:51], v[200:203], v[96:99]
    ds_read_b64_tr_b16 v[36:37], v21 offset:8192
    v_mfma_f32_16x16x32_bf16 v[112:115], v[48:51], v[204:207], v[112:115]
    ds_read_b64_tr_b16 v[38:39], v21 offset:9216
    v_mfma_f32_16x16x32_bf16 v[68:71], v[52:55], v[192:195], v[68:71]
    ds_read_b64_tr_b16 v[40:41], v22 offset:8192
    v_mfma_f32_16x16x32_bf16 v[84:87], v[52:55], v[196:199], v[84:87]
    ds_read_b64_tr_b16 v[42:43], v22 offset:9216
    v_mfma_f32_16x16x32_bf16 v[100:103], v[52:55], v[200:203], v[100:103]
    ds_read_b64_tr_b16 v[44:45], v23 offset:8192
    v_mfma_f32_16x16x32_bf16 v[116:119], v[52:55], v[204:207], v[116:119]
    ds_read_b64_tr_b16 v[46:47], v23 offset:9216
    v_mfma_f32_16x16x32_bf16 v[72:75], v[56:59], v[192:195], v[72:75]
    v_mfma_f32_16x16x32_bf16 v[88:91], v[56:59], v[196:199], v[88:91]
    v_mfma_f32_16x16x32_bf16 v[104:107], v[56:59], v[200:203], v[104:107]
    v_mfma_f32_16x16x32_bf16 v[120:123], v[56:59], v[204:207], v[120:123]
    v_mfma_f32_16x16x32_bf16 v[76:79], v[60:63], v[192:195], v[76:79]
    v_mfma_f32_16x16x32_bf16 v[92:95], v[60:63], v[196:199], v[92:95]
    v_mfma_f32_16x16x32_bf16 v[108:111], v[60:63], v[200:203], v[108:111]
    v_mfma_f32_16x16x32_bf16 v[124:127], v[60:63], v[204:207], v[124:127]
    s_waitcnt vmcnt(0) lgkmcnt(0)
    v_mfma_f32_16x16x32_bf16 v[64:67], v[32:35], v[208:211], v[64:67]
    ds_read_b64_tr_b16 v[48:49], v20 offset:12288
    v_mfma_f32_16x16x32_bf16 v[80:83], v[32:35], v[212:215], v[80:83]
    ds_read_b64_tr_b16 v[50:51], v20 offset:13312
    v_mfma_f32_16x16x32_bf16 v[96:99], v[32:35], v[216:219], v[96:99]
    ds_read_b64_tr_b16 v[52:53], v21 offset:12288
    v_mfma_f32_16x16x32_bf16 v[112:115], v[32:35], v[220:223], v[112:115]
    ds_read_b64_tr_b16 v[54:55], v21 offset:13312
    v_mfma_f32_16x16x32_bf16 v[68:71], v[36:39], v[208:211], v[68:71]
    ds_read_b64_tr_b16 v[56:57], v22 offset:12288
    v_mfma_f32_16x16x32_bf16 v[84:87], v[36:39], v[212:215], v[84:87]
    ds_read_b64_tr_b16 v[58:59], v22 offset:13312
    v_mfma_f32_16x16x32_bf16 v[100:103], v[36:39], v[216:219], v[100:103]
    ds_read_b64_tr_b16 v[60:61], v23 offset:12288
    v_mfma_f32_16x16x32_bf16 v[116:119], v[36:39], v[220:223], v[116:119]
    ds_read_b64_tr_b16 v[62:63], v23 offset:13312
    v_mfma_f32_16x16x32_bf16 v[72:75], v[40:43], v[208:211], v[72:75]
    v_mfma_f32_16x16x32_bf16 v[88:91], v[40:43], v[212:215], v[88:91]
    v_mfma_f32_16x16x32_bf16 v[104:107], v[40:43], v[216:219], v[104:107]
    v_mfma_f32_16x16x32_bf16 v[120:123], v[40:43], v[220:223], v[120:123]
    v_mfma_f32_16x16x32_bf16 v[76:79], v[44:47], v[208:211], v[76:79]
    v_mfma_f32_16x16x32_bf16 v[92:95], v[44:47], v[212:215], v[92:95]
    v_mfma_f32_16x16x32_bf16 v[108:111], v[44:47], v[216:219], v[108:111]
    v_mfma_f32_16x16x32_bf16 v[124:127], v[44:47], v[220:223], v[124:127]
    s_waitcnt vmcnt(8) lgkmcnt(0)
    v_mul_u32_u24 v9, 272, v3
    v_lshl_add_u32 v9, v4, 4, v9
    s_mul_i32 s42, s16, 17408
    v_add_u32 v9, s42, v9
    s_cmp_lg_u32 s16, 0
    s_cbranch_scc1 K3_nopoll
    s_lshl_b32 s42, s34, 5
    v_mov_b32 v224, s42
    s_mov_b32 s48, 0
    buffer_load_dword v225, v224, s[84:87], 0 offen sc1
    s_branch K3_poll2
K3_poll:
    buffer_load_dword v225, v224, s[84:87], 0 offen sc0 sc1
K3_poll2:
    s_waitcnt vmcnt(0)
    v_readfirstlane_b32 s42, v225
    s_cmp_ge_u32 s42, 32
    s_cbranch_scc1 K3_nopoll
    s_add_u32 s48, s48, 1
    s_cmp_ge_u32 s48, 0x40000
    s_cbranch_scc1 K3_nopoll
    s_sleep 16
    s_branch K3_poll
K3_nopoll:
    s_barrier
    v_lshrrev_b32 v224, 2, v0
    v_and_b32 v225, 3, v0
    v_lshlrev_b32 v226, 12, v224
    v_lshl_add_u32 v226, v225, 5, v226
    v_lshlrev_b32 v227, 7, v224
    v_lshl_add_u32 v227, v225, 5, v227
    v_add_u32 v227, 69632, v227
    s_lshl_b32 s36, s34, 18
    s_lshl_b32 s37, s33, 7
    s_add_u32 s36, s36, s37
    s_add_u32 s36, s36, 0x1000000
    buffer_load_dwordx4 v[128:131], v226, s[8:11], s36 offen sc1
    buffer_load_dwordx4 v[132:135], v226, s[8:11], s36 offen offset:16 sc1
    v_mfma_f32_16x16x32_bf16 v[64:67], v[48:51], a[0:3], v[64:67]
    v_mfma_f32_16x16x32_bf16 v[80:83], v[48:51], a[4:7], v[80:83]
    v_mfma_f32_16x16x32_bf16 v[96:99], v[48:51], a[8:11], v[96:99]
    v_mfma_f32_16x16x32_bf16 v[112:115], v[48:51], a[12:15], v[112:115]
    v_mfma_f32_16x16x32_bf16 v[68:71], v[52:55], a[0:3], v[68:71]
    v_mfma_f32_16x16x32_bf16 v[84:87], v[52:55], a[4:7], v[84:87]
    v_mfma_f32_16x16x32_bf16 v[100:103], v[52:55], a[8:11], v[100:103]
    v_mfma_f32_16x16x32_bf16 v[116:119], v[52:55], a[12:15], v[116:119]
    v_mfma_f32_16x16x32_bf16 v[72:75], v[56:59], a[0:3], v[72:75]
    v_mfma_f32_16x16x32_bf16 v[88:91], v[56:59], a[4:7], v[88:91]
    v_mfma_f32_16x16x32_bf16 v[104:107], v[56:59], a[8:11], v[104:107]
    v_mfma_f32_16x16x32_bf16 v[120:123], v[56:59], a[12:15], v[120:123]
    v_mfma_f32_16x16x32_bf16 v[76:79], v[60:63], a[0:3], v[76:79]
    v_mfma_f32_16x16x32_bf16 v[92:95], v[60:63], a[4:7], v[92:95]
    v_mfma_f32_16x16x32_bf16 v[108:111], v[60:63], a[8:11], v[108:111]
    v_mfma_f32_16x16x32_bf16 v[124:127], v[60:63], a[12:15], v[124:127]
    s_barrier
    ds_write_b128 v9, v[64:67] offset:0
    ds_write_b128 v9, v[68:71] offset:64
    ds_write_b128 v9, v[72:75] offset:128
    s_nop 0
    ds_write_b128 v9, v[76:79] offset:192
    ds_write_b128 v9, v[80:83] offset:4352
    ds_write_b128 v9, v[84:87] offset:4416
    ds_write_b128 v9, v[88:91] offset:4480
    ds_write_b128 v9, v[92:95] offset:4544
    ds_write_b128 v9, v[96:99] offset:8704
    ds_write_b128 v9, v[100:103] offset:8768
    ds_write_b128 v9, v[104:107] offset:8832
    ds_write_b128 v9, v[108:111] offset:8896
    ds_write_b128 v9, v[112:115] offset:13056
    ds_write_b128 v9, v[116:119] offset:13120
    ds_write_b128 v9, v[120:123] offset:13184
    ds_write_b128 v9, v[124:127] offset:13248
    v_mul_u32_u24 v8, 272, v3
    v_lshl_add_u32 v8, v4, 6, v8
    s_mul_i32 s42, s16, 4352
    v_add_u32 v8, s42, v8
    v_lshrrev_b32 v14, 2, v3
    v_lshl_add_u32 v14, v4, 4, v14
    v_lshlrev_b32 v14, 7, v14
    v_and_b32 v15, 3, v1
    v_lshl_add_u32 v14, v15, 3, v14
    s_lshl_b32 s42, s16, 5
    s_add_u32 s42, s42, 69632
    v_add_u32 v14, s42, v14
    s_waitcnt vmcnt(0)
    ds_write_b128 v227, v[128:131]
    ds_write_b128 v227, v[132:135] offset:16
    s_waitcnt lgkmcnt(0)
    s_barrier
    ds_read_b64_tr_b16 v[32:33], v14 offset:0
    ds_read_b64_tr_b16 v[34:35], v14 offset:512
    ds_read_b64_tr_b16 v[36:37], v14 offset:1024
    ds_read_b64_tr_b16 v[38:39], v14 offset:1536
    ds_read_b128 v[64:67], v8 offset:0
    ds_read_b128 v[68:71], v8 offset:16
    ds_read_b128 v[72:75], v8 offset:32
    ds_read_b128 v[76:79], v8 offset:48
    ds_read_b128 v[80:83], v8 offset:17408
    ds_read_b128 v[84:87], v8 offset:17424
    ds_read_b128 v[88:91], v8 offset:17440
    ds_read_b128 v[92:95], v8 offset:17456
    s_waitcnt lgkmcnt(4)
    ds_read_b128 v[96:99], v8 offset:34816
    ds_read_b128 v[100:103], v8 offset:34832
    ds_read_b128 v[104:107], v8 offset:34848
    ds_read_b128 v[108:111], v8 offset:34864
    ds_read_b128 v[112:115], v8 offset:52224
    ds_read_b128 v[116:119], v8 offset:52240
    ds_read_b128 v[120:123], v8 offset:52256
    ds_read_b128 v[124:127], v8 offset:52272
    s_waitcnt lgkmcnt(0)
    v_add_f32 v64, v64, v80
    v_add_f32 v96, v96, v112
    v_add_f32 v65, v65, v81
    v_add_f32 v97, v97, v113
    v_add_f32 v66, v66, v82
    v_add_f32 v98, v98, v114
    v_add_f32 v67, v67, v83
    v_add_f32 v99, v99, v115
    v_add_f32 v68, v68, v84
    v_add_f32 v100, v100, v116
    v_add_f32 v69, v69, v85
    v_add_f32 v101, v101, v117
    v_add_f32 v70, v70, v86
    v_add_f32 v102, v102, v118
    v_add_f32 v71, v71, v87
    v_add_f32 v103, v103, v119
    v_add_f32 v72, v72, v88
    v_add_f32 v104, v104, v120
    v_add_f32 v73, v73, v89
    v_add_f32 v105, v105, v121
    v_add_f32 v74, v74, v90
    v_add_f32 v106, v106, v122
    v_add_f32 v75, v75, v91
    v_add_f32 v107, v107, v123
    v_add_f32 v76, v76, v92
    v_add_f32 v108, v108, v124
    v_add_f32 v77, v77, v93
    v_add_f32 v109, v109, v125
    v_add_f32 v78, v78, v94
    v_add_f32 v110, v110, v126
    v_add_f32 v79, v79, v95
    v_add_f32 v111, v111, v127
    v_add_f32 v64, v64, v96
    v_add_f32 v65, v65, v97
    v_add_f32 v66, v66, v98
    v_add_f32 v67, v67, v99
    v_add_f32 v68, v68, v100
    v_add_f32 v69, v69, v101
    v_add_f32 v70, v70, v102
    v_add_f32 v71, v71, v103
    v_add_f32 v72, v72, v104
    v_add_f32 v73, v73, v105
    v_add_f32 v74, v74, v106
    v_add_f32 v75, v75, v107
    v_add_f32 v76, v76, v108
    v_add_f32 v77, v77, v109
    v_add_f32 v78, v78, v110
    v_add_f32 v79, v79, v111
    v_cvt_pk_bf16_f32 v64, v64, v65
    v_lshlrev_b32 v40, 16, v24
    v_and_b32 v41, 0xffff0000, v24
    v_lshlrev_b32 v42, 16, v32
    v_and_b32 v43, 0xffff0000, v32
    v_add_f32 v40, v40, v42
    v_add_f32 v41, v41, v43
    v_and_b32 v65, 0xffff0000, v64
    v_lshlrev_b32 v64, 16, v64
    v_cvt_pk_bf16_f32 v40, v40, v41
    v_and_b32 v41, 0xffff0000, v40
    v_lshlrev_b32 v40, 16, v40
    v_add_f32 v40, v40, v64
    v_add_f32 v41, v41, v65
    v_cvt_pk_bf16_f32 v48, v40, v41
    v_cvt_pk_bf16_f32 v66, v66, v67
    v_lshlrev_b32 v40, 16, v25
    v_and_b32 v41, 0xffff0000, v25
    v_lshlrev_b32 v42, 16, v33
    v_and_b32 v43, 0xffff0000, v33
    v_add_f32 v40, v40, v42
    v_add_f32 v41, v41, v43
    v_and_b32 v67, 0xffff0000, v66
    v_lshlrev_b32 v66, 16, v66
    v_cvt_pk_bf16_f32 v40, v40, v41
    v_and_b32 v41, 0xffff0000, v40
    v_lshlrev_b32 v40, 16, v40
    v_add_f32 v40, v40, v66
    v_add_f32 v41, v41, v67
    v_cvt_pk_bf16_f32 v49, v40, v41
    v_cvt_pk_bf16_f32 v68, v68, v69
    v_lshlrev_b32 v40, 16, v26
    v_and_b32 v41, 0xffff0000, v26
    v_lshlrev_b32 v42, 16, v34
    v_and_b32 v43, 0xffff0000, v34
    v_add_f32 v40, v40, v42
    v_add_f32 v41, v41, v43
    v_and_b32 v69, 0xffff0000, v68
    v_lshlrev_b32 v68, 16, v68
    v_cvt_pk_bf16_f32 v40, v40, v41
    v_and_b32 v41, 0xffff0000, v40
    v_lshlrev_b32 v40, 16, v40
    v_add_f32 v40, v40, v68
    v_add_f32 v41, v41, v69
    v_cvt_pk_bf16_f32 v50, v40, v41
    v_cvt_pk_bf16_f32 v70, v70, v71
    v_lshlrev_b32 v40, 16, v27
    v_and_b32 v41, 0xffff0000, v27
    v_lshlrev_b32 v42, 16, v35
    v_and_b32 v43, 0xffff0000, v35
    v_add_f32 v40, v40, v42
    v_add_f32 v41, v41, v43
    v_and_b32 v71, 0xffff0000, v70
    v_lshlrev_b32 v70, 16, v70
    v_cvt_pk_bf16_f32 v40, v40, v41
    v_and_b32 v41, 0xffff0000, v40
    v_lshlrev_b32 v40, 16, v40
    v_add_f32 v40, v40, v70
    v_add_f32 v41, v41, v71
    v_cvt_pk_bf16_f32 v51, v40, v41
    v_cvt_pk_bf16_f32 v72, v72, v73
    v_lshlrev_b32 v40, 16, v28
    v_and_b32 v41, 0xffff0000, v28
    v_lshlrev_b32 v42, 16, v36
    v_and_b32 v43, 0xffff0000, v36
    v_add_f32 v40, v40, v42
    v_add_f32 v41, v41, v43
    v_and_b32 v73, 0xffff0000, v72
    v_lshlrev_b32 v72, 16, v72
    v_cvt_pk_bf16_f32 v40, v40, v41
    v_and_b32 v41, 0xffff0000, v40
    v_lshlrev_b32 v40, 16, v40
    v_add_f32 v40, v40, v72
    v_add_f32 v41, v41, v73
    v_cvt_pk_bf16_f32 v52, v40, v41
    v_cvt_pk_bf16_f32 v74, v74, v75
    v_lshlrev_b32 v40, 16, v29
    v_and_b32 v41, 0xffff0000, v29
    v_lshlrev_b32 v42, 16, v37
    v_and_b32 v43, 0xffff0000, v37
    v_add_f32 v40, v40, v42
    v_add_f32 v41, v41, v43
    v_and_b32 v75, 0xffff0000, v74
    v_lshlrev_b32 v74, 16, v74
    v_cvt_pk_bf16_f32 v40, v40, v41
    v_and_b32 v41, 0xffff0000, v40
    v_lshlrev_b32 v40, 16, v40
    v_add_f32 v40, v40, v74
    v_add_f32 v41, v41, v75
    v_cvt_pk_bf16_f32 v53, v40, v41
    v_cvt_pk_bf16_f32 v76, v76, v77
    v_lshlrev_b32 v40, 16, v30
    v_and_b32 v41, 0xffff0000, v30
    v_lshlrev_b32 v42, 16, v38
    v_and_b32 v43, 0xffff0000, v38
    v_add_f32 v40, v40, v42
    v_add_f32 v41, v41, v43
    v_and_b32 v77, 0xffff0000, v76
    v_lshlrev_b32 v76, 16, v76
    v_cvt_pk_bf16_f32 v40, v40, v41
    v_and_b32 v41, 0xffff0000, v40
    v_lshlrev_b32 v40, 16, v40
    v_add_f32 v40, v40, v76
    v_add_f32 v41, v41, v77
    v_cvt_pk_bf16_f32 v54, v40, v41
    v_cvt_pk_bf16_f32 v78, v78, v79
    v_lshlrev_b32 v40, 16, v31
    v_and_b32 v41, 0xffff0000, v31
    v_lshlrev_b32 v42, 16, v39
    v_and_b32 v43, 0xffff0000, v39
    v_add_f32 v40, v40, v42
    v_add_f32 v41, v41, v43
    v_and_b32 v79, 0xffff0000, v78
    v_lshlrev_b32 v78, 16, v78
    v_cvt_pk_bf16_f32 v40, v40, v41
    v_and_b32 v41, 0xffff0000, v40
    v_lshlrev_b32 v40, 16, v40
    v_add_f32 v40, v40, v78
    v_add_f32 v41, v41, v79
    v_cvt_pk_bf16_f32 v55, v40, v41
    buffer_store_dwordx4 v[48:51], v6, s[20:23], s35 offen
    buffer_store_dwordx4 v[52:55], v6, s[20:23], s35 offen offset:16
    s_endpgm
K3_conv:
    s_load_dwordx2 s[62:63], s[0:1], 48
    s_and_b32 s19, s2, 7
    s_lshr_b32 s20, s2, 3
    s_lshl_b32 s51, s19, 6
    s_lshl_b32 s21, s20, 1
    s_add_u32 s51, s51, s21
    s_lshl_b32 s19, s51, 1
    s_and_b32 s31, s16, 1
    s_lshr_b32 s32, s16, 1
    s_add_u32 s33, s51, s32
    s_mul_i32 s34, s32, 14912
    s_add_u32 s34, s34, 4608
    s_lshl_b32 s35, s31, 7
    v_add_u32 v5, s35, v1
    v_sub_u32 v6, 0xff, v5
    v_lshlrev_b32 v6, 13, v6
    s_lshl_b32 s36, s33, 4
    s_add_u32 s36, s36, 0x200000
    s_lshl_b32 s37, s31, 11
    s_add_u32 s37, s37, s34
    s_mov_b32 s8, s4
    s_mov_b32 s9, s5
    s_mov_b32 s10, 0x1200000
    s_mov_b32 s11, 0x00020000
    s_mov_b32 m0, s37
    s_nop 0
    buffer_load_dwordx4 v6, s[8:11], s36 offen lds
    v_subrev_u32 v6, 0x80000, v6
    s_add_u32 s37, s37, 1024
    s_mov_b32 m0, s37
    s_nop 0
    buffer_load_dwordx4 v6, s[8:11], s36 offen lds
    s_mul_i32 s36, s33, 4160
    s_add_u32 s36, s36, 0x400000
    s_lshl_b32 s38, s31, 1
    s_add_u32 s36, s36, s38
    s_mul_i32 s37, s31, 5184
    s_add_u32 s37, s37, s34
    s_add_u32 s37, s37, 4608
    s_mov_b32 m0, s37
    s_nop 0
    buffer_load_dwordx4 v7, s[8:11], s36 offen lds
    s_add_u32 s36, s36, 1024
    s_add_u32 s37, s37, 1024
    s_mov_b32 m0, s37
    s_nop 0
    buffer_load_dwordx4 v7, s[8:11], s36 offen lds
    s_add_u32 s36, s36, 1024
    s_add_u32 s37, s37, 1024
    s_mov_b32 m0, s37
    s_nop 0
    buffer_load_dwordx4 v7, s[8:11], s36 offen lds
    s_add_u32 s36, s36, 1024
    s_add_u32 s37, s37, 1024
    s_mov_b32 m0, s37
    s_nop 0
    buffer_load_dwordx4 v7, s[8:11], s36 offen lds
    s_add_u32 s36, s36, 1024
    s_add_u32 s37, s37, 1024
    s_mov_b64 exec, 0xff
    s_mov_b32 m0, s37
    s_nop 0
    buffer_load_dwordx4 v7, s[8:11], s36 offen lds
    s_mov_b64 exec, -1
    s_lshl_b32 s21, s33, 2
    s_add_u32 s21, s21, 0x680000
    s_load_dword s47, s[4:5], s21
    s_waitcnt lgkmcnt(0)
    s_load_dword s30, s[62:63], s19
    v_mov_b32 v16, 0
    v_mov_b32 v17, 0
    v_mov_b32 v18, 0
    v_mov_b32 v19, 0
    v_add_u32 v9, s34, v7
    s_mov_b64 exec, 0xffffffff
    ds_write_b128 v9, v[16:19] offset:4096
    s_mov_b64 exec, -1
    s_waitcnt lgkmcnt(0)
    s_lshl_b32 s21, s32, 4
    s_lshr_b32 s48, s30, s21
    s_lshl_b32 s48, s48, 16
    v_lshlrev_b32 v15, 5, v3
    v_lshlrev_b32 v16, 4, v4
    s_lshl_b32 s45, s31, 8
    s_add_u32 s46, s34, s45
    s_add_u32 s21, s46, 480
    v_sub_u32 v20, v16, v15
    v_add_u32 v20, s21, v20
    s_add_u32 s21, s46, 4610
    v_lshl_add_u32 v21, v3, 1, v16
    v_add_u32 v21, s21, v21
    v_and_b32 v17, 1, v3
    v_xor_b32 v17, 1, v17
    v_mul_u32_u24 v17, 5182, v17
    v_add_u32 v21, v21, v17
    v_add_u32 v28, 1024, v21
    v_add_u32 v29, 2048, v21
    v_add_u32 v30, 3072, v21
    v_lshlrev_b32 v17, 3, v4
    v_add_u32 v22, v15, v17
    s_add_u32 s21, s34, 504
    v_sub_u32 v23, s21, v22
    s_waitcnt vmcnt(0) lgkmcnt(0)
    s_barrier
    ds_read_b128 v[96:99], v20 offset:3584
    ds_read2_b32 v[128:129], v21 offset0:0 offset1:1
    ds_read2_b32 v[130:131], v21 offset0:2 offset1:3
    ds_read_b128 v[100:103], v20 offset:3072
    ds_read2_b32 v[132:133], v21 offset0:128 offset1:129
    ds_read2_b32 v[134:135], v21 offset0:130 offset1:131
    ds_read_b128 v[104:107], v20 offset:2560
    ds_read2_b32 v[136:137], v28 offset0:0 offset1:1
    ds_read2_b32 v[138:139], v28 offset0:2 offset1:3
    ds_read_b128 v[108:111], v20 offset:2048
    ds_read2_b32 v[140:141], v28 offset0:128 offset1:129
    ds_read2_b32 v[142:143], v28 offset0:130 offset1:131
    ds_read_b128 v[112:115], v20 offset:1536
    ds_read2_b32 v[144:145], v29 offset0:0 offset1:1
    ds_read2_b32 v[146:147], v29 offset0:2 offset1:3
    ds_read_b128 v[116:119], v20 offset:1024
    ds_read2_b32 v[148:149], v29 offset0:128 offset1:129
    ds_read2_b32 v[150:151], v29 offset0:130 offset1:131
    ds_read_b128 v[120:123], v20 offset:512
    ds_read2_b32 v[152:153], v30 offset0:0 offset1:1
    ds_read2_b32 v[154:155], v30 offset0:2 offset1:3
    ds_read_b128 v[124:127], v20 offset:0
    ds_read2_b32 v[156:157], v30 offset0:128 offset1:129
    ds_read2_b32 v[158:159], v30 offset0:130 offset1:131
    s_waitcnt lgkmcnt(0)
    v_mfma_f32_16x16x32_f16 v[64:67], v[128:131], v[96:99], 0
    ds_read_b128 v[160:163], v20 offset:3648
    v_mfma_f32_16x16x32_f16 v[68:71], v[128:131], v[100:103], 0
    ds_read2_b32 v[192:193], v21 offset0:16 offset1:17
    v_mfma_f32_16x16x32_f16 v[72:75], v[128:131], v[104:107], 0
    ds_read2_b32 v[194:195], v21 offset0:18 offset1:19
    v_mfma_f32_16x16x32_f16 v[76:79], v[128:131], v[108:111], 0
    ds_read_b128 v[164:167], v20 offset:3136
    v_mfma_f32_16x16x32_f16 v[80:83], v[128:131], v[112:115], 0
    ds_read2_b32 v[196:197], v21 offset0:144 offset1:145
    v_mfma_f32_16x16x32_f16 v[84:87], v[128:131], v[116:119], 0
    ds_read2_b32 v[198:199], v21 offset0:146 offset1:147
    v_mfma_f32_16x16x32_f16 v[88:91], v[128:131], v[120:123], 0
    ds_read_b128 v[168:171], v20 offset:2624
    v_mfma_f32_16x16x32_f16 v[92:95], v[128:131], v[124:127], 0
    ds_read2_b32 v[200:201], v28 offset0:16 offset1:17
    v_mfma_f32_16x16x32_f16 v[68:71], v[132:135], v[96:99], v[68:71]
    ds_read2_b32 v[202:203], v28 offset0:18 offset1:19
    v_mfma_f32_16x16x32_f16 v[72:75], v[132:135], v[100:103], v[72:75]
    ds_read_b128 v[172:175], v20 offset:2112
    v_mfma_f32_16x16x32_f16 v[76:79], v[132:135], v[104:107], v[76:79]
    ds_read2_b32 v[204:205], v28 offset0:144 offset1:145
    v_mfma_f32_16x16x32_f16 v[80:83], v[132:135], v[108:111], v[80:83]
    ds_read2_b32 v[206:207], v28 offset0:146 offset1:147
    v_mfma_f32_16x16x32_f16 v[84:87], v[132:135], v[112:115], v[84:87]
    ds_read_b128 v[176:179], v20 offset:1600
    v_mfma_f32_16x16x32_f16 v[88:91], v[132:135], v[116:119], v[88:91]
    ds_read2_b32 v[208:209], v29 offset0:16 offset1:17
    v_mfma_f32_16x16x32_f16 v[92:95], v[132:135], v[120:123], v[92:95]
    ds_read2_b32 v[210:211], v29 offset0:18 offset1:19
    v_mfma_f32_16x16x32_f16 v[72:75], v[136:139], v[96:99], v[72:75]
    ds_read_b128 v[180:183], v20 offset:1088
    v_mfma_f32_16x16x32_f16 v[76:79], v[136:139], v[100:103], v[76:79]
    ds_read2_b32 v[212:213], v29 offset0:144 offset1:145
    v_mfma_f32_16x16x32_f16 v[80:83], v[136:139], v[104:107], v[80:83]
    ds_read2_b32 v[214:215], v29 offset0:146 offset1:147
    v_mfma_f32_16x16x32_f16 v[84:87], v[136:139], v[108:111], v[84:87]
    ds_read_b128 v[184:187], v20 offset:576
    v_mfma_f32_16x16x32_f16 v[88:91], v[136:139], v[112:115], v[88:91]
    ds_read2_b32 v[216:217], v30 offset0:16 offset1:17
    v_mfma_f32_16x16x32_f16 v[92:95], v[136:139], v[116:119], v[92:95]
    ds_read2_b32 v[218:219], v30 offset0:18 offset1:19
    v_mfma_f32_16x16x32_f16 v[76:79], v[140:143], v[96:99], v[76:79]
    ds_read_b128 v[188:191], v20 offset:64
    v_mfma_f32_16x16x32_f16 v[80:83], v[140:143], v[100:103], v[80:83]
    ds_read2_b32 v[220:221], v30 offset0:144 offset1:145
    v_mfma_f32_16x16x32_f16 v[84:87], v[140:143], v[104:107], v[84:87]
    ds_read2_b32 v[222:223], v30 offset0:146 offset1:147
    v_mfma_f32_16x16x32_f16 v[88:91], v[140:143], v[108:111], v[88:91]
    v_mfma_f32_16x16x32_f16 v[92:95], v[140:143], v[112:115], v[92:95]
    v_mfma_f32_16x16x32_f16 v[80:83], v[144:147], v[96:99], v[80:83]
    v_mfma_f32_16x16x32_f16 v[84:87], v[144:147], v[100:103], v[84:87]
    v_mfma_f32_16x16x32_f16 v[88:91], v[144:147], v[104:107], v[88:91]
    v_mfma_f32_16x16x32_f16 v[92:95], v[144:147], v[108:111], v[92:95]
    v_mfma_f32_16x16x32_f16 v[84:87], v[148:151], v[96:99], v[84:87]
    v_mfma_f32_16x16x32_f16 v[88:91], v[148:151], v[100:103], v[88:91]
    v_mfma_f32_16x16x32_f16 v[92:95], v[148:151], v[104:107], v[92:95]
    v_mfma_f32_16x16x32_f16 v[88:91], v[152:155], v[96:99], v[88:91]
    v_mfma_f32_16x16x32_f16 v[92:95], v[152:155], v[100:103], v[92:95]
    v_mfma_f32_16x16x32_f16 v[92:95], v[156:159], v[96:99], v[92:95]
    s_waitcnt lgkmcnt(0)
    v_mfma_f32_16x16x32_f16 v[64:67], v[192:195], v[160:163], v[64:67]
    ds_read_b128 v[96:99], v20 offset:3712
    v_mfma_f32_16x16x32_f16 v[68:71], v[192:195], v[164:167], v[68:71]
    ds_read2_b32 v[128:129], v21 offset0:32 offset1:33
    v_mfma_f32_16x16x32_f16 v[72:75], v[192:195], v[168:171], v[72:75]
    ds_read2_b32 v[130:131], v21 offset0:34 offset1:35
    v_mfma_f32_16x16x32_f16 v[76:79], v[192:195], v[172:175], v[76:79]
    ds_read_b128 v[100:103], v20 offset:3200
    v_mfma_f32_16x16x32_f16 v[80:83], v[192:195], v[176:179], v[80:83]
    ds_read2_b32 v[132:133], v21 offset0:160 offset1:161
    v_mfma_f32_16x16x32_f16 v[84:87], v[192:195], v[180:183], v[84:87]
    ds_read2_b32 v[134:135], v21 offset0:162 offset1:163
    v_mfma_f32_16x16x32_f16 v[88:91], v[192:195], v[184:187], v[88:91]
    ds_read_b128 v[104:107], v20 offset:2688
    v_mfma_f32_16x16x32_f16 v[92:95], v[192:195], v[188:191], v[92:95]
    ds_read2_b32 v[136:137], v28 offset0:32 offset1:33
    v_mfma_f32_16x16x32_f16 v[68:71], v[196:199], v[160:163], v[68:71]
    ds_read2_b32 v[138:139], v28 offset0:34 offset1:35
    v_mfma_f32_16x16x32_f16 v[72:75], v[196:199], v[164:167], v[72:75]
    ds_read_b128 v[108:111], v20 offset:2176
    v_mfma_f32_16x16x32_f16 v[76:79], v[196:199], v[168:171], v[76:79]
    ds_read2_b32 v[140:141], v28 offset0:160 offset1:161
    v_mfma_f32_16x16x32_f16 v[80:83], v[196:199], v[172:175], v[80:83]
    ds_read2_b32 v[142:143], v28 offset0:162 offset1:163
    v_mfma_f32_16x16x32_f16 v[84:87], v[196:199], v[176:179], v[84:87]
    ds_read_b128 v[112:115], v20 offset:1664
    v_mfma_f32_16x16x32_f16 v[88:91], v[196:199], v[180:183], v[88:91]
    ds_read2_b32 v[144:145], v29 offset0:32 offset1:33
    v_mfma_f32_16x16x32_f16 v[92:95], v[196:199], v[184:187], v[92:95]
    ds_read2_b32 v[146:147], v29 offset0:34 offset1:35
    v_mfma_f32_16x16x32_f16 v[72:75], v[200:203], v[160:163], v[72:75]
    ds_read_b128 v[116:119], v20 offset:1152
    v_mfma_f32_16x16x32_f16 v[76:79], v[200:203], v[164:167], v[76:79]
    ds_read2_b32 v[148:149], v29 offset0:160 offset1:161
    v_mfma_f32_16x16x32_f16 v[80:83], v[200:203], v[168:171], v[80:83]
    ds_read2_b32 v[150:151], v29 offset0:162 offset1:163
    v_mfma_f32_16x16x32_f16 v[84:87], v[200:203], v[172:175], v[84:87]
    ds_read_b128 v[120:123], v20 offset:640
    v_mfma_f32_16x16x32_f16 v[88:91], v[200:203], v[176:179], v[88:91]
    ds_read2_b32 v[152:153], v30 offset0:32 offset1:33
    v_mfma_f32_16x16x32_f16 v[92:95], v[200:203], v[180:183], v[92:95]
    ds_read2_b32 v[154:155], v30 offset0:34 offset1:35
    v_mfma_f32_16x16x32_f16 v[76:79], v[204:207], v[160:163], v[76:79]
    ds_read_b128 v[124:127], v20 offset:128
    v_mfma_f32_16x16x32_f16 v[80:83], v[204:207], v[164:167], v[80:83]
    ds_read2_b32 v[156:157], v30 offset0:160 offset1:161
    v_mfma_f32_16x16x32_f16 v[84:87], v[204:207], v[168:171], v[84:87]
    ds_read2_b32 v[158:159], v30 offset0:162 offset1:163
    v_mfma_f32_16x16x32_f16 v[88:91], v[204:207], v[172:175], v[88:91]
    v_mfma_f32_16x16x32_f16 v[92:95], v[204:207], v[176:179], v[92:95]
    v_mfma_f32_16x16x32_f16 v[80:83], v[208:211], v[160:163], v[80:83]
    v_mfma_f32_16x16x32_f16 v[84:87], v[208:211], v[164:167], v[84:87]
    v_mfma_f32_16x16x32_f16 v[88:91], v[208:211], v[168:171], v[88:91]
    v_mfma_f32_16x16x32_f16 v[92:95], v[208:211], v[172:175], v[92:95]
    v_mfma_f32_16x16x32_f16 v[84:87], v[212:215], v[160:163], v[84:87]
    v_mfma_f32_16x16x32_f16 v[88:91], v[212:215], v[164:167], v[88:91]
    v_mfma_f32_16x16x32_f16 v[92:95], v[212:215], v[168:171], v[92:95]
    v_mfma_f32_16x16x32_f16 v[88:91], v[216:219], v[160:163], v[88:91]
    v_mfma_f32_16x16x32_f16 v[92:95], v[216:219], v[164:167], v[92:95]
    v_mfma_f32_16x16x32_f16 v[92:95], v[220:223], v[160:163], v[92:95]
    s_waitcnt lgkmcnt(0)
    v_mfma_f32_16x16x32_f16 v[64:67], v[128:131], v[96:99], v[64:67]
    ds_read_b128 v[160:163], v20 offset:3776
    v_mfma_f32_16x16x32_f16 v[68:71], v[128:131], v[100:103], v[68:71]
    ds_read2_b32 v[192:193], v21 offset0:48 offset1:49
    v_mfma_f32_16x16x32_f16 v[72:75], v[128:131], v[104:107], v[72:75]
    ds_read2_b32 v[194:195], v21 offset0:50 offset1:51
    v_mfma_f32_16x16x32_f16 v[76:79], v[128:131], v[108:111], v[76:79]
    ds_read_b128 v[164:167], v20 offset:3264
    v_mfma_f32_16x16x32_f16 v[80:83], v[128:131], v[112:115], v[80:83]
    ds_read2_b32 v[196:197], v21 offset0:176 offset1:177
    v_mfma_f32_16x16x32_f16 v[84:87], v[128:131], v[116:119], v[84:87]
    ds_read2_b32 v[198:199], v21 offset0:178 offset1:179
    v_mfma_f32_16x16x32_f16 v[88:91], v[128:131], v[120:123], v[88:91]
    ds_read_b128 v[168:171], v20 offset:2752
    v_mfma_f32_16x16x32_f16 v[92:95], v[128:131], v[124:127], v[92:95]
    ds_read2_b32 v[200:201], v28 offset0:48 offset1:49
    v_mfma_f32_16x16x32_f16 v[68:71], v[132:135], v[96:99], v[68:71]
    ds_read2_b32 v[202:203], v28 offset0:50 offset1:51
    v_mfma_f32_16x16x32_f16 v[72:75], v[132:135], v[100:103], v[72:75]
    ds_read_b128 v[172:175], v20 offset:2240
    v_mfma_f32_16x16x32_f16 v[76:79], v[132:135], v[104:107], v[76:79]
    ds_read2_b32 v[204:205], v28 offset0:176 offset1:177
    v_mfma_f32_16x16x32_f16 v[80:83], v[132:135], v[108:111], v[80:83]
    ds_read2_b32 v[206:207], v28 offset0:178 offset1:179
    v_mfma_f32_16x16x32_f16 v[84:87], v[132:135], v[112:115], v[84:87]
    ds_read_b128 v[176:179], v20 offset:1728
    v_mfma_f32_16x16x32_f16 v[88:91], v[132:135], v[116:119], v[88:91]
    ds_read2_b32 v[208:209], v29 offset0:48 offset1:49
    v_mfma_f32_16x16x32_f16 v[92:95], v[132:135], v[120:123], v[92:95]
    ds_read2_b32 v[210:211], v29 offset0:50 offset1:51
    v_mfma_f32_16x16x32_f16 v[72:75], v[136:139], v[96:99], v[72:75]
    ds_read_b128 v[180:183], v20 offset:1216
    v_mfma_f32_16x16x32_f16 v[76:79], v[136:139], v[100:103], v[76:79]
    ds_read2_b32 v[212:213], v29 offset0:176 offset1:177
    v_mfma_f32_16x16x32_f16 v[80:83], v[136:139], v[104:107], v[80:83]
    ds_read2_b32 v[214:215], v29 offset0:178 offset1:179
    v_mfma_f32_16x16x32_f16 v[84:87], v[136:139], v[108:111], v[84:87]
    ds_read_b128 v[184:187], v20 offset:704
    v_mfma_f32_16x16x32_f16 v[88:91], v[136:139], v[112:115], v[88:91]
    ds_read2_b32 v[216:217], v30 offset0:48 offset1:49
    v_mfma_f32_16x16x32_f16 v[92:95], v[136:139], v[116:119], v[92:95]
    ds_read2_b32 v[218:219], v30 offset0:50 offset1:51
    v_mfma_f32_16x16x32_f16 v[76:79], v[140:143], v[96:99], v[76:79]
    ds_read_b128 v[188:191], v20 offset:192
    v_mfma_f32_16x16x32_f16 v[80:83], v[140:143], v[100:103], v[80:83]
    ds_read2_b32 v[220:221], v30 offset0:176 offset1:177
    v_mfma_f32_16x16x32_f16 v[84:87], v[140:143], v[104:107], v[84:87]
    ds_read2_b32 v[222:223], v30 offset0:178 offset1:179
    v_mfma_f32_16x16x32_f16 v[88:91], v[140:143], v[108:111], v[88:91]
    v_mfma_f32_16x16x32_f16 v[92:95], v[140:143], v[112:115], v[92:95]
    v_mfma_f32_16x16x32_f16 v[80:83], v[144:147], v[96:99], v[80:83]
    v_mfma_f32_16x16x32_f16 v[84:87], v[144:147], v[100:103], v[84:87]
    v_mfma_f32_16x16x32_f16 v[88:91], v[144:147], v[104:107], v[88:91]
    v_mfma_f32_16x16x32_f16 v[92:95], v[144:147], v[108:111], v[92:95]
    v_mfma_f32_16x16x32_f16 v[84:87], v[148:151], v[96:99], v[84:87]
    v_mfma_f32_16x16x32_f16 v[88:91], v[148:151], v[100:103], v[88:91]
    v_mfma_f32_16x16x32_f16 v[92:95], v[148:151], v[104:107], v[92:95]
    v_mfma_f32_16x16x32_f16 v[88:91], v[152:155], v[96:99], v[88:91]
    v_mfma_f32_16x16x32_f16 v[92:95], v[152:155], v[100:103], v[92:95]
    v_mfma_f32_16x16x32_f16 v[92:95], v[156:159], v[96:99], v[92:95]
    s_waitcnt lgkmcnt(0)
    v_mfma_f32_16x16x32_f16 v[64:67], v[192:195], v[160:163], v[64:67]
    v_mfma_f32_16x16x32_f16 v[68:71], v[192:195], v[164:167], v[68:71]
    v_mfma_f32_16x16x32_f16 v[72:75], v[192:195], v[168:171], v[72:75]
    v_mfma_f32_16x16x32_f16 v[76:79], v[192:195], v[172:175], v[76:79]
    v_mfma_f32_16x16x32_f16 v[80:83], v[192:195], v[176:179], v[80:83]
    v_mfma_f32_16x16x32_f16 v[84:87], v[192:195], v[180:183], v[84:87]
    v_mfma_f32_16x16x32_f16 v[88:91], v[192:195], v[184:187], v[88:91]
    v_mfma_f32_16x16x32_f16 v[92:95], v[192:195], v[188:191], v[92:95]
    v_mfma_f32_16x16x32_f16 v[68:71], v[196:199], v[160:163], v[68:71]
    v_mfma_f32_16x16x32_f16 v[72:75], v[196:199], v[164:167], v[72:75]
    v_mfma_f32_16x16x32_f16 v[76:79], v[196:199], v[168:171], v[76:79]
    v_mfma_f32_16x16x32_f16 v[80:83], v[196:199], v[172:175], v[80:83]
    v_mfma_f32_16x16x32_f16 v[84:87], v[196:199], v[176:179], v[84:87]
    v_mfma_f32_16x16x32_f16 v[88:91], v[196:199], v[180:183], v[88:91]
    v_mfma_f32_16x16x32_f16 v[92:95], v[196:199], v[184:187], v[92:95]
    v_mfma_f32_16x16x32_f16 v[72:75], v[200:203], v[160:163], v[72:75]
    v_mfma_f32_16x16x32_f16 v[76:79], v[200:203], v[164:167], v[76:79]
    v_mfma_f32_16x16x32_f16 v[80:83], v[200:203], v[168:171], v[80:83]
    v_mfma_f32_16x16x32_f16 v[84:87], v[200:203], v[172:175], v[84:87]
    v_mfma_f32_16x16x32_f16 v[88:91], v[200:203], v[176:179], v[88:91]
    v_mfma_f32_16x16x32_f16 v[92:95], v[200:203], v[180:183], v[92:95]
    v_mfma_f32_16x16x32_f16 v[76:79], v[204:207], v[160:163], v[76:79]
    v_mfma_f32_16x16x32_f16 v[80:83], v[204:207], v[164:167], v[80:83]
    v_mfma_f32_16x16x32_f16 v[84:87], v[204:207], v[168:171], v[84:87]
    v_mfma_f32_16x16x32_f16 v[88:91], v[204:207], v[172:175], v[88:91]
    v_mfma_f32_16x16x32_f16 v[92:95], v[204:207], v[176:179], v[92:95]
    v_mfma_f32_16x16x32_f16 v[80:83], v[208:211], v[160:163], v[80:83]
    v_mfma_f32_16x16x32_f16 v[84:87], v[208:211], v[164:167], v[84:87]
    v_mfma_f32_16x16x32_f16 v[88:91], v[208:211], v[168:171], v[88:91]
    v_mfma_f32_16x16x32_f16 v[92:95], v[208:211], v[172:175], v[92:95]
    v_mfma_f32_16x16x32_f16 v[84:87], v[212:215], v[160:163], v[84:87]
    v_mfma_f32_16x16x32_f16 v[88:91], v[212:215], v[164:167], v[88:91]
    v_mfma_f32_16x16x32_f16 v[92:95], v[212:215], v[168:171], v[92:95]
    v_mfma_f32_16x16x32_f16 v[88:91], v[216:219], v[160:163], v[88:91]
    v_mfma_f32_16x16x32_f16 v[92:95], v[216:219], v[164:167], v[92:95]
    v_mfma_f32_16x16x32_f16 v[92:95], v[220:223], v[160:163], v[92:95]
    s_lshl_b32 s45, s16, 12
    s_add_u32 s45, s45, 34432
    v_add_u32 v24, s45, v7
    s_xor_b32 s46, s16, 1
    s_lshl_b32 s46, s46, 12
    s_add_u32 s46, s46, 34432
    v_add_u32 v25, s46, v7
    s_cmp_eq_u32 s31, 0
    s_cbranch_scc0 K3_x1
    ds_write_b128 v24, v[80:83] offset:0
    ds_write_b128 v24, v[84:87] offset:1024
    ds_write_b128 v24, v[88:91] offset:2048
    ds_write_b128 v24, v[92:95] offset:3072
    s_branch K3_x2
K3_x1:
    s_nop 7
    s_nop 1
    ds_write_b128 v24, v[64:67] offset:0
    ds_write_b128 v24, v[68:71] offset:1024
    ds_write_b128 v24, v[72:75] offset:2048
    ds_write_b128 v24, v[76:79] offset:3072
K3_x2:
    s_waitcnt lgkmcnt(0)
    s_barrier
    s_lshl_b32 s50, s33, 12
    s_add_u32 s50, s50, 0x1000000
    s_cmp_eq_u32 s31, 0
    s_cbranch_scc0 K3_e1
    ds_read_b128 v[96:99], v25 offset:0
    ds_read_b64 v[112:113], v23 offset:3584
    ds_read_b128 v[100:103], v25 offset:1024
    ds_read_b64 v[114:115], v23 offset:3072
    ds_read_b128 v[104:107], v25 offset:2048
    ds_read_b64 v[116:117], v23 offset:2560
    ds_read_b128 v[108:111], v25 offset:3072
    ds_read_b64 v[118:119], v23 offset:2048
    s_waitcnt lgkmcnt(0)
    v_add_f32 v64, v64, v96
    v_add_f32 v65, v65, v97
    v_add_f32 v66, v66, v98
    v_add_f32 v67, v67, v99
    v_mul_f32 v64, s47, v64
    v_mul_f32 v65, s47, v65
    v_mul_f32 v66, s47, v66
    v_mul_f32 v67, s47, v67
    v_cvt_f32_f16 v123, v112
    v_lshrrev_b32 v122, 16, v112
    v_cvt_f32_f16 v122, v122
    v_cvt_f32_f16 v121, v113
    v_lshrrev_b32 v120, 16, v113
    v_cvt_f32_f16 v120, v120
    v_mul_f32 v120, s48, v120
    v_mul_f32 v121, s48, v121
    v_mul_f32 v122, s48, v122
    v_mul_f32 v123, s48, v123
    v_cvt_pk_bf16_f32 v64, v64, v65
    v_cvt_pk_bf16_f32 v66, v66, v67
    v_cvt_pk_bf16_f32 v120, v120, v121
    v_cvt_pk_bf16_f32 v122, v122, v123
    v_and_b32 v65, 0xffff0000, v64
    v_lshlrev_b32 v64, 16, v64
    v_and_b32 v67, 0xffff0000, v66
    v_lshlrev_b32 v66, 16, v66
    v_and_b32 v121, 0xffff0000, v120
    v_lshlrev_b32 v120, 16, v120
    v_and_b32 v123, 0xffff0000, v122
    v_lshlrev_b32 v122, 16, v122
    v_add_f32 v64, v64, v120
    v_add_f32 v65, v65, v121
    v_add_f32 v66, v66, v122
    v_add_f32 v67, v67, v123
    v_cvt_pk_bf16_f32 v124, v64, v65
    v_cvt_pk_bf16_f32 v125, v66, v67
    buffer_store_dwordx2 v[124:125], v22, s[8:11], s50 offen offset:0 sc1
    v_add_f32 v68, v68, v100
    v_add_f32 v69, v69, v101
    v_add_f32 v70, v70, v102
    v_add_f32 v71, v71, v103
    v_mul_f32 v68, s47, v68
    v_mul_f32 v69, s47, v69
    v_mul_f32 v70, s47, v70
    v_mul_f32 v71, s47, v71
    v_cvt_f32_f16 v123, v114
    v_lshrrev_b32 v122, 16, v114
    v_cvt_f32_f16 v122, v122
    v_cvt_f32_f16 v121, v115
    v_lshrrev_b32 v120, 16, v115
    v_cvt_f32_f16 v120, v120
    v_mul_f32 v120, s48, v120
    v_mul_f32 v121, s48, v121
    v_mul_f32 v122, s48, v122
    v_mul_f32 v123, s48, v123
    v_cvt_pk_bf16_f32 v68, v68, v69
    v_cvt_pk_bf16_f32 v70, v70, v71
    v_cvt_pk_bf16_f32 v120, v120, v121
    v_cvt_pk_bf16_f32 v122, v122, v123
    v_and_b32 v69, 0xffff0000, v68
    v_lshlrev_b32 v68, 16, v68
    v_and_b32 v71, 0xffff0000, v70
    v_lshlrev_b32 v70, 16, v70
    v_and_b32 v121, 0xffff0000, v120
    v_lshlrev_b32 v120, 16, v120
    v_and_b32 v123, 0xffff0000, v122
    v_lshlrev_b32 v122, 16, v122
    v_add_f32 v68, v68, v120
    v_add_f32 v69, v69, v121
    v_add_f32 v70, v70, v122
    v_add_f32 v71, v71, v123
    v_cvt_pk_bf16_f32 v126, v68, v69
    v_cvt_pk_bf16_f32 v127, v70, v71
    buffer_store_dwordx2 v[126:127], v22, s[8:11], s50 offen offset:512 sc1
    v_add_f32 v72, v72, v104
    v_add_f32 v73, v73, v105
    v_add_f32 v74, v74, v106
    v_add_f32 v75, v75, v107
    v_mul_f32 v72, s47, v72
    v_mul_f32 v73, s47, v73
    v_mul_f32 v74, s47, v74
    v_mul_f32 v75, s47, v75
    v_cvt_f32_f16 v123, v116
    v_lshrrev_b32 v122, 16, v116
    v_cvt_f32_f16 v122, v122
    v_cvt_f32_f16 v121, v117
    v_lshrrev_b32 v120, 16, v117
    v_cvt_f32_f16 v120, v120
    v_mul_f32 v120, s48, v120
    v_mul_f32 v121, s48, v121
    v_mul_f32 v122, s48, v122
    v_mul_f32 v123, s48, v123
    v_cvt_pk_bf16_f32 v72, v72, v73
    v_cvt_pk_bf16_f32 v74, v74, v75
    v_cvt_pk_bf16_f32 v120, v120, v121
    v_cvt_pk_bf16_f32 v122, v122, v123
    v_and_b32 v73, 0xffff0000, v72
    v_lshlrev_b32 v72, 16, v72
    v_and_b32 v75, 0xffff0000, v74
    v_lshlrev_b32 v74, 16, v74
    v_and_b32 v121, 0xffff0000, v120
    v_lshlrev_b32 v120, 16, v120
    v_and_b32 v123, 0xffff0000, v122
    v_lshlrev_b32 v122, 16, v122
    v_add_f32 v72, v72, v120
    v_add_f32 v73, v73, v121
    v_add_f32 v74, v74, v122
    v_add_f32 v75, v75, v123
    v_cvt_pk_bf16_f32 v128, v72, v73
    v_cvt_pk_bf16_f32 v129, v74, v75
    buffer_store_dwordx2 v[128:129], v22, s[8:11], s50 offen offset:1024 sc1
    v_add_f32 v76, v76, v108
    v_add_f32 v77, v77, v109
    v_add_f32 v78, v78, v110
    v_add_f32 v79, v79, v111
    v_mul_f32 v76, s47, v76
    v_mul_f32 v77, s47, v77
    v_mul_f32 v78, s47, v78
    v_mul_f32 v79, s47, v79
    v_cvt_f32_f16 v123, v118
    v_lshrrev_b32 v122, 16, v118
    v_cvt_f32_f16 v122, v122
    v_cvt_f32_f16 v121, v119
    v_lshrrev_b32 v120, 16, v119
    v_cvt_f32_f16 v120, v120
    v_mul_f32 v120, s48, v120
    v_mul_f32 v121, s48, v121
    v_mul_f32 v122, s48, v122
    v_mul_f32 v123, s48, v123
    v_cvt_pk_bf16_f32 v76, v76, v77
    v_cvt_pk_bf16_f32 v78, v78, v79
    v_cvt_pk_bf16_f32 v120, v120, v121
    v_cvt_pk_bf16_f32 v122, v122, v123
    v_and_b32 v77, 0xffff0000, v76
    v_lshlrev_b32 v76, 16, v76
    v_and_b32 v79, 0xffff0000, v78
    v_lshlrev_b32 v78, 16, v78
    v_and_b32 v121, 0xffff0000, v120
    v_lshlrev_b32 v120, 16, v120
    v_and_b32 v123, 0xffff0000, v122
    v_lshlrev_b32 v122, 16, v122
    v_add_f32 v76, v76, v120
    v_add_f32 v77, v77, v121
    v_add_f32 v78, v78, v122
    v_add_f32 v79, v79, v123
    v_cvt_pk_bf16_f32 v130, v76, v77
    v_cvt_pk_bf16_f32 v131, v78, v79
    buffer_store_dwordx2 v[130:131], v22, s[8:11], s50 offen offset:1536 sc1
    s_branch K3_e2
K3_e1:
    ds_read_b128 v[96:99], v25 offset:0
    ds_read_b64 v[112:113], v23 offset:1536
    ds_read_b128 v[100:103], v25 offset:1024
    ds_read_b64 v[114:115], v23 offset:1024
    ds_read_b128 v[104:107], v25 offset:2048
    ds_read_b64 v[116:117], v23 offset:512
    ds_read_b128 v[108:111], v25 offset:3072
    ds_read_b64 v[118:119], v23 offset:0
    s_waitcnt lgkmcnt(0)
    v_add_f32 v80, v80, v96
    v_add_f32 v81, v81, v97
    v_add_f32 v82, v82, v98
    v_add_f32 v83, v83, v99
    v_mul_f32 v80, s47, v80
    v_mul_f32 v81, s47, v81
    v_mul_f32 v82, s47, v82
    v_mul_f32 v83, s47, v83
    v_cvt_f32_f16 v123, v112
    v_lshrrev_b32 v122, 16, v112
    v_cvt_f32_f16 v122, v122
    v_cvt_f32_f16 v121, v113
    v_lshrrev_b32 v120, 16, v113
    v_cvt_f32_f16 v120, v120
    v_mul_f32 v120, s48, v120
    v_mul_f32 v121, s48, v121
    v_mul_f32 v122, s48, v122
    v_mul_f32 v123, s48, v123
    v_cvt_pk_bf16_f32 v80, v80, v81
    v_cvt_pk_bf16_f32 v82, v82, v83
    v_cvt_pk_bf16_f32 v120, v120, v121
    v_cvt_pk_bf16_f32 v122, v122, v123
    v_and_b32 v81, 0xffff0000, v80
    v_lshlrev_b32 v80, 16, v80
    v_and_b32 v83, 0xffff0000, v82
    v_lshlrev_b32 v82, 16, v82
    v_and_b32 v121, 0xffff0000, v120
    v_lshlrev_b32 v120, 16, v120
    v_and_b32 v123, 0xffff0000, v122
    v_lshlrev_b32 v122, 16, v122
    v_add_f32 v80, v80, v120
    v_add_f32 v81, v81, v121
    v_add_f32 v82, v82, v122
    v_add_f32 v83, v83, v123
    v_cvt_pk_bf16_f32 v124, v80, v81
    v_cvt_pk_bf16_f32 v125, v82, v83
    buffer_store_dwordx2 v[124:125], v22, s[8:11], s50 offen offset:2048 sc1
    v_add_f32 v84, v84, v100
    v_add_f32 v85, v85, v101
    v_add_f32 v86, v86, v102
    v_add_f32 v87, v87, v103
    v_mul_f32 v84, s47, v84
    v_mul_f32 v85, s47, v85
    v_mul_f32 v86, s47, v86
    v_mul_f32 v87, s47, v87
    v_cvt_f32_f16 v123, v114
    v_lshrrev_b32 v122, 16, v114
    v_cvt_f32_f16 v122, v122
    v_cvt_f32_f16 v121, v115
    v_lshrrev_b32 v120, 16, v115
    v_cvt_f32_f16 v120, v120
    v_mul_f32 v120, s48, v120
    v_mul_f32 v121, s48, v121
    v_mul_f32 v122, s48, v122
    v_mul_f32 v123, s48, v123
    v_cvt_pk_bf16_f32 v84, v84, v85
    v_cvt_pk_bf16_f32 v86, v86, v87
    v_cvt_pk_bf16_f32 v120, v120, v121
    v_cvt_pk_bf16_f32 v122, v122, v123
    v_and_b32 v85, 0xffff0000, v84
    v_lshlrev_b32 v84, 16, v84
    v_and_b32 v87, 0xffff0000, v86
    v_lshlrev_b32 v86, 16, v86
    v_and_b32 v121, 0xffff0000, v120
    v_lshlrev_b32 v120, 16, v120
    v_and_b32 v123, 0xffff0000, v122
    v_lshlrev_b32 v122, 16, v122
    v_add_f32 v84, v84, v120
    v_add_f32 v85, v85, v121
    v_add_f32 v86, v86, v122
    v_add_f32 v87, v87, v123
    v_cvt_pk_bf16_f32 v126, v84, v85
    v_cvt_pk_bf16_f32 v127, v86, v87
    buffer_store_dwordx2 v[126:127], v22, s[8:11], s50 offen offset:2560 sc1
    v_add_f32 v88, v88, v104
    v_add_f32 v89, v89, v105
    v_add_f32 v90, v90, v106
    v_add_f32 v91, v91, v107
    v_mul_f32 v88, s47, v88
    v_mul_f32 v89, s47, v89
    v_mul_f32 v90, s47, v90
    v_mul_f32 v91, s47, v91
    v_cvt_f32_f16 v123, v116
    v_lshrrev_b32 v122, 16, v116
    v_cvt_f32_f16 v122, v122
    v_cvt_f32_f16 v121, v117
    v_lshrrev_b32 v120, 16, v117
    v_cvt_f32_f16 v120, v120
    v_mul_f32 v120, s48, v120
    v_mul_f32 v121, s48, v121
    v_mul_f32 v122, s48, v122
    v_mul_f32 v123, s48, v123
    v_cvt_pk_bf16_f32 v88, v88, v89
    v_cvt_pk_bf16_f32 v90, v90, v91
    v_cvt_pk_bf16_f32 v120, v120, v121
    v_cvt_pk_bf16_f32 v122, v122, v123
    v_and_b32 v89, 0xffff0000, v88
    v_lshlrev_b32 v88, 16, v88
    v_and_b32 v91, 0xffff0000, v90
    v_lshlrev_b32 v90, 16, v90
    v_and_b32 v121, 0xffff0000, v120
    v_lshlrev_b32 v120, 16, v120
    v_and_b32 v123, 0xffff0000, v122
    v_lshlrev_b32 v122, 16, v122
    v_add_f32 v88, v88, v120
    v_add_f32 v89, v89, v121
    v_add_f32 v90, v90, v122
    v_add_f32 v91, v91, v123
    v_cvt_pk_bf16_f32 v128, v88, v89
    v_cvt_pk_bf16_f32 v129, v90, v91
    buffer_store_dwordx2 v[128:129], v22, s[8:11], s50 offen offset:3072 sc1
    v_add_f32 v92, v92, v108
    v_add_f32 v93, v93, v109
    v_add_f32 v94, v94, v110
    v_add_f32 v95, v95, v111
    v_mul_f32 v92, s47, v92
    v_mul_f32 v93, s47, v93
    v_mul_f32 v94, s47, v94
    v_mul_f32 v95, s47, v95
    v_cvt_f32_f16 v123, v118
    v_lshrrev_b32 v122, 16, v118
    v_cvt_f32_f16 v122, v122
    v_cvt_f32_f16 v121, v119
    v_lshrrev_b32 v120, 16, v119
    v_cvt_f32_f16 v120, v120
    v_mul_f32 v120, s48, v120
    v_mul_f32 v121, s48, v121
    v_mul_f32 v122, s48, v122
    v_mul_f32 v123, s48, v123
    v_cvt_pk_bf16_f32 v92, v92, v93
    v_cvt_pk_bf16_f32 v94, v94, v95
    v_cvt_pk_bf16_f32 v120, v120, v121
    v_cvt_pk_bf16_f32 v122, v122, v123
    v_and_b32 v93, 0xffff0000, v92
    v_lshlrev_b32 v92, 16, v92
    v_and_b32 v95, 0xffff0000, v94
    v_lshlrev_b32 v94, 16, v94
    v_and_b32 v121, 0xffff0000, v120
    v_lshlrev_b32 v120, 16, v120
    v_and_b32 v123, 0xffff0000, v122
    v_lshlrev_b32 v122, 16, v122
    v_add_f32 v92, v92, v120
    v_add_f32 v93, v93, v121
    v_add_f32 v94, v94, v122
    v_add_f32 v95, v95, v123
    v_cvt_pk_bf16_f32 v130, v92, v93
    v_cvt_pk_bf16_f32 v131, v94, v95
    buffer_store_dwordx2 v[130:131], v22, s[8:11], s50 offen offset:3584 sc1
K3_e2:
    s_waitcnt vmcnt(0)
    s_barrier
    s_cmp_lg_u32 s16, 0
    s_cbranch_scc1 K3_done
    s_and_b32 s21, s2, 7
    s_lshl_b32 s21, s21, 5
    v_mov_b32 v8, s21
    v_mov_b32 v9, 1
    s_mov_b64 exec, 1
    buffer_atomic_add v9, v8, s[84:87], 0 offen
K3_done:
    s_endpgm
.section .rodata,"a"
.p2align 6
.amdhsa_kernel k3_kernel
  .amdhsa_next_free_vgpr 248
  .amdhsa_next_free_sgpr 100
  .amdhsa_accum_offset 232
  .amdhsa_group_segment_fixed_size 0
  .amdhsa_kernarg_size 112
  .amdhsa_user_sgpr_count 2
  .amdhsa_user_sgpr_kernarg_segment_ptr 1
  .amdhsa_system_sgpr_workgroup_id_x 1
  .amdhsa_float_denorm_mode_32 3
.end_amdhsa_kernel
```
